```python
import torch

def _softmax(x, axis=-1):
    return torch.softmax(x, dim=axis)
def _gelu(x):
    return torch.nn.functional.gelu(x, approximate="tanh")
def _silu(x):
    return torch.nn.functional.silu(x)
def _sigmoid(x):
    return torch.sigmoid(x)
def _layernorm(x, axis=-1, eps=1e-5):
    m = x.mean(dim=axis, keepdim=True)
    v = x.var(dim=axis, keepdim=True, unbiased=False)
    return (x - m) / torch.sqrt(v + eps)
def _scatter_add(tgt, idx, src, axis=0):
    return tgt.clone().index_add_(axis, idx, src)
def _segment_sum(src, seg, n):
    out = torch.zeros((n,) + src.shape[1:], dtype=src.dtype)
    return out.index_add_(0, seg, src)
def _pad(x, pw):
    flat = tuple(v for pair in reversed(pw) for v in pair)
    return torch.nn.functional.pad(x, flat)

kernel_name = 'concat_heads__gqa_block_cached__compressed_kv_cla__decode'

def setup_inputs():

    _w = (lambda a: (lambda t: t.to(torch.bfloat16) if t.is_floating_point() else t)(torch.as_tensor(a)))
    def _A_setup():
        B, Sq, D = 4, 1, 576
        Hq, Hkv, Sk, Dh = 32, 16, 4096, 128
        assert Hq % Hkv == 0, (Hq, Hkv)
        return {
            "x": _w((lambda *s: torch.randn(*s, dtype=torch.bfloat16) * 1.6)(B, Sq, D)),
            "k_cache": _w((lambda *s: torch.randn(*s, dtype=torch.bfloat16) * 1.6)(B, Hkv, Sk, Dh)),
            "v_cache": _w((lambda *s: torch.randn(*s, dtype=torch.bfloat16) * 0.05)(B, Hkv, Sk, Dh)),
            "wq": _w((lambda *s: torch.randn(*s, dtype=torch.bfloat16) * 1.6)(D, Hq * Dh) * (D ** -0.5)),
            "wo": _w((lambda *s: torch.randn(*s, dtype=torch.bfloat16) * 0.05)(Hq * Dh, D) * ((Hq * Dh) ** -0.5)),
        }
    _A_in = _A_setup()

    def _B_setup():
        B, H, Sq, Sk, D, M = 4, 32, 1, 4096, 128, 576
        Dc = 4 * D
        return {
            "x": _w((lambda *s: torch.randn(*s, dtype=torch.bfloat16) * 3.2)(B, Sq, M)),
            "c_kv": _w((lambda *s: torch.randn(*s, dtype=torch.bfloat16) * 0.1)(B, Sk, Dc)),
            "w_q": _w((lambda *s: torch.randn(*s, dtype=torch.bfloat16) * 6.4)(M, H, D) * (M ** -0.5)),
            "w_uk": _w((lambda *s: torch.randn(*s, dtype=torch.bfloat16) * 6.4)(Dc, H, D) * (Dc ** -0.5)),
            "w_uv": _w((lambda *s: torch.randn(*s, dtype=torch.bfloat16) * 0.1)(Dc, H, D) * (Dc ** -0.5)),
            "w_o": _w((lambda *s: torch.randn(*s, dtype=torch.bfloat16) * 0.1)(H, D, M) * ((H * D) ** -0.5)),
        }
    _B_in = _B_setup()

    return {
        "A_x": _A_in["x"],
        "A_k_cache": _A_in["k_cache"],
        "A_v_cache": _A_in["v_cache"],
        "A_wq": _A_in["wq"],
        "A_wo": _A_in["wo"],
        "B_x": _B_in["x"],
        "B_c_kv": _B_in["c_kv"],
        "B_w_q": _B_in["w_q"],
        "B_w_uk": _B_in["w_uk"],
        "B_w_uv": _B_in["w_uv"],
        "B_w_o": _B_in["w_o"],
    }

def reference(A_x, A_k_cache, A_v_cache, A_wq, A_wo, B_x, B_c_kv, B_w_q, B_w_uk, B_w_uv, B_w_o):
    def _A_ref(x, k_cache, v_cache, wq, wo):
        B, Sq, D = x.shape
        Hq, Dh = 32, 128
        Hkv = k_cache.shape[1]
        rep = Hq // Hkv
        q = (lambda x, *d: x.permute(*d))((x @ wq).reshape(B, Sq, Hq, Dh), 0, 2, 1, 3)
        k = (lambda x, n, axis: torch.repeat_interleave(x, n, dim=axis))(k_cache, rep, axis=1)
        v = (lambda x, n, axis: torch.repeat_interleave(x, n, dim=axis))(v_cache, rep, axis=1)
        scores = torch.einsum("bhqd,bhkd->bhqk", q, k) * (Dh ** -0.5)
        p = _softmax(scores, axis=-1)
        o = torch.einsum("bhqk,bhkd->bhqd", p, v)
        return (lambda x, *d: x.permute(*d))(o, 0, 2, 1, 3).reshape(B, Sq, Hq * Dh) @ wo

    def _B_ref(x, c_kv, w_q, w_uk, w_uv, w_o):
        B, Sq, M = x.shape[0], x.shape[1], x.shape[2]
        Sk = c_kv.shape[1]
        H, D = w_q.shape[1], w_q.shape[2]
        q = torch.einsum("bqm,mhd->bhqd", x, w_q)
        k = torch.einsum("bkc,chd->bhkd", c_kv, w_uk)
        v = torch.einsum("bkc,chd->bhkd", c_kv, w_uv)
        scores = torch.einsum("bhqd,bhkd->bhqk", q, k) * (D ** -0.5)
        off = Sk - Sq
        qi = torch.arange(Sq)[:, None]
        kj = torch.arange(Sk)[None, :]
        cmask = kj <= (qi + off)
        scores = torch.where(cmask[None, None], scores, -1e9)
        p = _softmax(scores, axis=-1)
        ctx = torch.einsum("bhqk,bhkd->bhqd", p, v)
        return torch.einsum("bhqd,hdm->bqm", ctx, w_o)

    a = _A_ref(A_x, A_k_cache, A_v_cache, A_wq, A_wo)
    b = _B_ref(B_x, B_c_kv, B_w_q, B_w_uk, B_w_uv, B_w_o)
    return torch.concatenate([a, b], axis=-1)
```

```asm
; @launch grid=(256,1,1) block=(512,1,1) lds=163840
.amdgcn_target "amdgcn-amd-amdhsa--gfx950"
.text
.globl concat_heads__gqa_block_cached__compressed_kv_cla__decode_kernel
.p2align 8
.type concat_heads__gqa_block_cached__compressed_kv_cla__decode_kernel,@function
concat_heads__gqa_block_cached__compressed_kv_cla__decode_kernel:
L_code0:
  s_cmp_ge_u32 s2, 256
  s_cbranch_scc1 L_exit
  s_load_dwordx16 s[16:31], s[0:1], 0
  s_load_dwordx8 s[32:39], s[0:1], 64
  s_load_dwordx4 s[40:43], s[0:1], 96
  v_lshrrev_b32 v2, 6, v0
  v_and_b32 v1, 63, v0
  v_readfirstlane_b32 s3, v2
  s_lshr_b32 s7, s2, 3
  s_and_b32 s12, s2, s7
  s_and_b32 s12, s12, 3
  s_bcnt1_i32_b32 s12, s12
  s_and_b32 s12, s12, 1
  s_lshr_b32 s4, s2, 2
  s_xor_b32 s4, s4, s12
  s_lshr_b32 s5, s2, 5
  s_add_u32 s5, s5, s7
  s_add_u32 s5, s2, s5
  s_and_b32 s5, s5, 3
  s_and_b32 s11, s3, 3
  s_mov_b32 s8, 0x05040100
  s_mov_b32 s9, 0x07060302
  s_mov_b32 s10, 0x3e0293ee
  s_cmp_eq_u32 s5, 3
  s_cbranch_scc1 L_xwg
  s_cmp_ge_u32 s3, 4
  s_cbranch_scc1 L_s47
  s_setprio 3
  s_waitcnt lgkmcnt(0)
  s_load_dword s6, s[42:43], 0
  s_mov_b32 s44, s42
  s_mov_b32 s45, s43
  s_mov_b32 s46, 0x10000000
  s_mov_b32 s47, 0x20000
  s_and_b32 s7, s4, 33
  s_or_b32 s7, s7, s5
  s_or_b32 s7, s7, s3
  s_cmp_lg_u32 s7, 0
  s_cbranch_scc1 L_pi_1
  v_lshlrev_b32 v2, 12, v1
  v_mov_b32 v3, 0
  s_lshl_b32 s7, s4, 7
  s_add_u32 s7, s7, 0x4000
  s_mov_b64 exec, 15
  buffer_store_dword v3, v2, s[44:47], s7 offen sc1
  s_mov_b64 exec, -1
L_pi_1:
  s_cmp_lt_u32 s4, 32
  s_cselect_b32 s48, s22, s30
  s_cselect_b32 s49, s23, s31
  s_cselect_b32 s52, s16, s26
  s_cselect_b32 s53, s17, s27
  s_mov_b32 s50, 4718592
  s_mov_b32 s51, 0x20000
  s_mov_b32 s54, 4608
  s_mov_b32 s55, 0x20000
  s_mul_i32 s12, s5, 192
  s_mul_i32 s7, s11, 48
  s_add_u32 s12, s12, s7
  s_lshl_b32 s13, s12, 13
  s_and_b32 s7, s4, 31
  s_lshl_b32 s7, s7, 8
  s_add_u32 s13, s13, s7
  v_lshrrev_b32 v10, 4, v1
  v_and_b32 v11, 15, v1
  v_lshlrev_b32 v12, 4, v11
  v_lshl_add_u32 v2, v10, 16, v12
  v_lshl_add_u32 v3, v10, 15, v12
  buffer_load_dwordx4 v[16:19], v2, s[48:51], s13 offen nt
  s_add_u32 s13, s13, 8192
  buffer_load_dwordx4 v[20:23], v2, s[48:51], s13 offen nt
  s_add_u32 s13, s13, 8192
  buffer_load_dwordx4 v[24:27], v2, s[48:51], s13 offen nt
  s_add_u32 s13, s13, 8192
  buffer_load_dwordx4 v[28:31], v2, s[48:51], s13 offen nt
  s_add_u32 s13, s13, 8192
  buffer_load_dwordx4 v[32:35], v2, s[48:51], s13 offen nt
  s_add_u32 s13, s13, 8192
  buffer_load_dwordx4 v[36:39], v2, s[48:51], s13 offen nt
  s_add_u32 s13, s13, 8192
  buffer_load_dwordx4 v[40:43], v2, s[48:51], s13 offen nt
  s_add_u32 s13, s13, 8192
  buffer_load_dwordx4 v[44:47], v2, s[48:51], s13 offen nt
  s_add_u32 s13, s13, 204800
  buffer_load_dwordx4 v[48:51], v3, s[48:51], s13 offen nt
  s_add_u32 s13, s13, 8192
  buffer_load_dwordx4 v[52:55], v3, s[48:51], s13 offen nt
  s_add_u32 s13, s13, 8192
  buffer_load_dwordx4 v[56:59], v3, s[48:51], s13 offen nt
  s_add_u32 s13, s13, 8192
  buffer_load_dwordx4 v[60:63], v3, s[48:51], s13 offen nt
  v_mul_u32_u24 v12, 1152, v11
  v_lshl_add_u32 v13, v10, 4, v12
  v_lshl_add_u32 v14, v10, 3, v12
  s_lshl_b32 s12, s12, 1
  buffer_load_dwordx4 v[4:7], v13, s[52:55], s12 offen
  buffer_load_dwordx2 v[8:9], v14, s[52:55], s12 offen offset:64
  s_waitcnt lgkmcnt(0)
  s_add_u32 s6, s6, 0x9e3779b9
  s_waitcnt vmcnt(6)
  s_barrier
  s_waitcnt vmcnt(6)
  v_perm_b32 v64, v20, v16, s8
  v_perm_b32 v65, v28, v24, s8
  v_perm_b32 v66, v36, v32, s8
  v_perm_b32 v67, v44, v40, s8
  v_perm_b32 v68, v20, v16, s9
  v_perm_b32 v69, v28, v24, s9
  v_perm_b32 v70, v36, v32, s9
  v_perm_b32 v71, v44, v40, s9
  v_perm_b32 v72, v21, v17, s8
  v_perm_b32 v73, v29, v25, s8
  v_perm_b32 v74, v37, v33, s8
  v_perm_b32 v75, v45, v41, s8
  v_perm_b32 v76, v21, v17, s9
  v_perm_b32 v77, v29, v25, s9
  v_perm_b32 v78, v37, v33, s9
  v_perm_b32 v79, v45, v41, s9
  v_perm_b32 v80, v22, v18, s8
  v_perm_b32 v81, v30, v26, s8
  v_perm_b32 v82, v38, v34, s8
  v_perm_b32 v83, v46, v42, s8
  v_perm_b32 v84, v22, v18, s9
  v_perm_b32 v85, v30, v26, s9
  v_perm_b32 v86, v38, v34, s9
  v_perm_b32 v87, v46, v42, s9
  v_perm_b32 v88, v23, v19, s8
  v_perm_b32 v89, v31, v27, s8
  v_perm_b32 v90, v39, v35, s8
  v_perm_b32 v91, v47, v43, s8
  v_perm_b32 v92, v23, v19, s9
  v_perm_b32 v93, v31, v27, s9
  v_perm_b32 v94, v39, v35, s9
  v_perm_b32 v95, v47, v43, s9
  s_waitcnt vmcnt(0)
  v_perm_b32 v96, v52, v48, s8
  v_perm_b32 v97, v60, v56, s8
  v_perm_b32 v98, v52, v48, s9
  v_perm_b32 v99, v60, v56, s9
  v_perm_b32 v100, v53, v49, s8
  v_perm_b32 v101, v61, v57, s8
  v_perm_b32 v102, v53, v49, s9
  v_perm_b32 v103, v61, v57, s9
  v_perm_b32 v104, v54, v50, s8
  v_perm_b32 v105, v62, v58, s8
  v_perm_b32 v106, v54, v50, s9
  v_perm_b32 v107, v62, v58, s9
  v_perm_b32 v108, v55, v51, s8
  v_perm_b32 v109, v63, v59, s8
  v_perm_b32 v110, v55, v51, s9
  v_perm_b32 v111, v63, v59, s9
  v_mfma_f32_16x16x32_bf16 v[112:115], v[4:7], v[64:67], 0
  v_mfma_f32_16x16x32_bf16 v[116:119], v[4:7], v[68:71], 0
  v_mfma_f32_16x16x32_bf16 v[120:123], v[4:7], v[72:75], 0
  v_mfma_f32_16x16x32_bf16 v[124:127], v[4:7], v[76:79], 0
  v_mfma_f32_16x16x32_bf16 v[128:131], v[4:7], v[80:83], 0
  v_mfma_f32_16x16x32_bf16 v[132:135], v[4:7], v[84:87], 0
  v_mfma_f32_16x16x32_bf16 v[136:139], v[4:7], v[88:91], 0
  v_mfma_f32_16x16x32_bf16 v[140:143], v[4:7], v[92:95], 0
  v_mfma_f32_16x16x16_bf16 v[112:115], v[8:9], v[96:97], v[112:115]
  v_mfma_f32_16x16x16_bf16 v[116:119], v[8:9], v[98:99], v[116:119]
  v_mfma_f32_16x16x16_bf16 v[120:123], v[8:9], v[100:101], v[120:123]
  v_mfma_f32_16x16x16_bf16 v[124:127], v[8:9], v[102:103], v[124:127]
  v_mfma_f32_16x16x16_bf16 v[128:131], v[8:9], v[104:105], v[128:131]
  v_mfma_f32_16x16x16_bf16 v[132:135], v[8:9], v[106:107], v[132:135]
  v_mfma_f32_16x16x16_bf16 v[136:139], v[8:9], v[108:109], v[136:139]
  v_mfma_f32_16x16x16_bf16 v[140:143], v[8:9], v[110:111], v[140:143]
  s_mul_i32 s7, s11, 2048
  s_add_u32 s7, s7, 15616
  v_lshlrev_b32 v2, 4, v1
  v_add_u32 v2, s7, v2
  s_mov_b64 exec, 0xffff
  ds_write_b128 v2, v[112:115] offset:0
  ds_write_b128 v2, v[116:119] offset:256
  ds_write_b128 v2, v[120:123] offset:512
  ds_write_b128 v2, v[124:127] offset:768
  ds_write_b128 v2, v[128:131] offset:1024
  ds_write_b128 v2, v[132:135] offset:1280
  ds_write_b128 v2, v[136:139] offset:1536
  ds_write_b128 v2, v[140:143] offset:1792
  s_mov_b64 exec, -1
  v_mov_b32 v3, 0
  v_mov_b32 v2, 1
  s_mov_b64 exec, 1
  ds_add_rtn_u32 v2, v3, v2
  s_waitcnt lgkmcnt(0)
  v_readfirstlane_b32 s12, v2
  s_mov_b64 exec, -1
  s_cmp_lg_u32 s12, 3
  s_nop 2
  s_cbranch_scc1 L_qs_2
  v_and_b32 v2, 15, v1
  v_lshlrev_b32 v2, 4, v2
  v_lshrrev_b32 v16, 4, v1
  v_lshl_add_u32 v2, v16, 2, v2
  ds_read_b32 v16, v2 offset:15616
  ds_read_b32 v17, v2 offset:15872
  ds_read_b32 v18, v2 offset:16128
  ds_read_b32 v19, v2 offset:16384
  ds_read_b32 v20, v2 offset:16640
  ds_read_b32 v21, v2 offset:16896
  ds_read_b32 v22, v2 offset:17152
  ds_read_b32 v23, v2 offset:17408
  ds_read_b32 v24, v2 offset:17664
  ds_read_b32 v25, v2 offset:17920
  ds_read_b32 v26, v2 offset:18176
  ds_read_b32 v27, v2 offset:18432
  ds_read_b32 v28, v2 offset:18688
  ds_read_b32 v29, v2 offset:18944
  ds_read_b32 v30, v2 offset:19200
  ds_read_b32 v31, v2 offset:19456
  ds_read_b32 v32, v2 offset:19712
  ds_read_b32 v33, v2 offset:19968
  ds_read_b32 v34, v2 offset:20224
  ds_read_b32 v35, v2 offset:20480
  ds_read_b32 v36, v2 offset:20736
  ds_read_b32 v37, v2 offset:20992
  ds_read_b32 v38, v2 offset:21248
  ds_read_b32 v39, v2 offset:21504
  ds_read_b32 v40, v2 offset:21760
  ds_read_b32 v41, v2 offset:22016
  ds_read_b32 v42, v2 offset:22272
  ds_read_b32 v43, v2 offset:22528
  ds_read_b32 v44, v2 offset:22784
  ds_read_b32 v45, v2 offset:23040
  ds_read_b32 v46, v2 offset:23296
  ds_read_b32 v47, v2 offset:23552
  s_waitcnt lgkmcnt(0)
  v_add_f32 v16, v16, v24
  v_add_f32 v32, v32, v40
  v_add_f32 v17, v17, v25
  v_add_f32 v33, v33, v41
  v_add_f32 v18, v18, v26
  v_add_f32 v34, v34, v42
  v_add_f32 v19, v19, v27
  v_add_f32 v35, v35, v43
  v_add_f32 v20, v20, v28
  v_add_f32 v36, v36, v44
  v_add_f32 v21, v21, v29
  v_add_f32 v37, v37, v45
  v_add_f32 v22, v22, v30
  v_add_f32 v38, v38, v46
  v_add_f32 v23, v23, v31
  v_add_f32 v39, v39, v47
  v_add_f32 v48, v16, v32
  v_add_f32 v49, v17, v33
  v_add_f32 v50, v18, v34
  v_add_f32 v52, v19, v35
  v_add_f32 v53, v20, v36
  v_add_f32 v54, v21, v37
  v_add_f32 v56, v22, v38
  v_add_f32 v57, v23, v39
  v_mov_b32 v51, s6
  v_mov_b32 v55, s6
  v_mov_b32 v58, s6
  v_mov_b32 v59, s6
  v_lshrrev_b32 v3, 4, v1
  v_mul_u32_u24 v2, 768, v3
  v_and_b32 v3, 15, v1
  v_lshl_add_u32 v2, v3, 4, v2
  s_mul_i32 s12, s4, 9216
  s_mul_i32 s13, s5, 3072
  s_add_u32 s12, s12, s13
  s_add_u32 s12, s12, 0x10000
  buffer_store_dwordx4 v[48:51], v2, s[44:47], s12 offen offset:0 sc1
  buffer_store_dwordx4 v[52:55], v2, s[44:47], s12 offen offset:256 sc1
  buffer_store_dwordx4 v[56:59], v2, s[44:47], s12 offen offset:512 sc1
  s_nop 1
L_qs_2:
  s_cmp_lg_u32 s3, 1
  s_cbranch_scc1 L_astart
  s_mov_b32 s56, s32
  s_mov_b32 s57, s33
  s_mov_b32 s59, 0x20000
  s_and_b32 s7, s4, 1
  s_add_u32 s58, s7, 1
  s_lshl_b32 s58, s58, 21
  s_lshl_b32 s7, s7, 3
  s_mul_i32 s12, s5, 3
  s_add_u32 s69, s7, s12
  s_lshl_b32 s7, s69, 18
  s_lshr_b32 s12, s4, 1
  s_lshl_b32 s12, s12, 8
  s_add_u32 s7, s7, s12
  v_bfe_u32 v3, v1, 2, 2
  v_lshlrev_b32 v2, 16, v3
  v_lshrrev_b32 v3, 4, v1
  v_lshl_add_u32 v2, v3, 6, v2
  v_and_b32 v3, 3, v1
  v_lshl_add_u32 v2, v3, 4, v2
  buffer_load_dwordx4 v[128:131], v2, s[56:59], s7 offen nt
  s_add_u32 s7, s7, 8192
  buffer_load_dwordx4 v[132:135], v2, s[56:59], s7 offen nt
  s_add_u32 s7, s7, 8192
  buffer_load_dwordx4 v[136:139], v2, s[56:59], s7 offen nt
  s_add_u32 s7, s7, 8192
  buffer_load_dwordx4 v[140:143], v2, s[56:59], s7 offen nt
  s_add_u32 s7, s7, 8192
  buffer_load_dwordx4 v[144:147], v2, s[56:59], s7 offen nt
  s_add_u32 s7, s7, 8192
  buffer_load_dwordx4 v[148:151], v2, s[56:59], s7 offen nt
  s_add_u32 s7, s7, 8192
  buffer_load_dwordx4 v[152:155], v2, s[56:59], s7 offen nt
  s_add_u32 s7, s7, 8192
  buffer_load_dwordx4 v[156:159], v2, s[56:59], s7 offen nt
  s_add_u32 s7, s7, 204800
  buffer_load_dwordx4 v[160:163], v2, s[56:59], s7 offen nt
  s_add_u32 s7, s7, 8192
  buffer_load_dwordx4 v[164:167], v2, s[56:59], s7 offen nt
  s_add_u32 s7, s7, 8192
  buffer_load_dwordx4 v[168:171], v2, s[56:59], s7 offen nt
  s_add_u32 s7, s7, 8192
  buffer_load_dwordx4 v[172:175], v2, s[56:59], s7 offen nt
  s_add_u32 s7, s7, 8192
  buffer_load_dwordx4 v[176:179], v2, s[56:59], s7 offen nt
  s_add_u32 s7, s7, 8192
  buffer_load_dwordx4 v[180:183], v2, s[56:59], s7 offen nt
  s_add_u32 s7, s7, 8192
  buffer_load_dwordx4 v[184:187], v2, s[56:59], s7 offen nt
  s_add_u32 s7, s7, 8192
  buffer_load_dwordx4 v[188:191], v2, s[56:59], s7 offen nt
  s_add_u32 s7, s7, 204800
  buffer_load_dwordx4 v[192:195], v2, s[56:59], s7 offen nt
  s_add_u32 s7, s7, 8192
  buffer_load_dwordx4 v[196:199], v2, s[56:59], s7 offen nt
  s_add_u32 s7, s7, 8192
  buffer_load_dwordx4 v[200:203], v2, s[56:59], s7 offen nt
  s_add_u32 s7, s7, 8192
  buffer_load_dwordx4 v[204:207], v2, s[56:59], s7 offen nt
  s_add_u32 s7, s7, 8192
  buffer_load_dwordx4 v[208:211], v2, s[56:59], s7 offen nt
  s_add_u32 s7, s7, 8192
  buffer_load_dwordx4 v[212:215], v2, s[56:59], s7 offen nt
  s_add_u32 s7, s7, 8192
  buffer_load_dwordx4 v[216:219], v2, s[56:59], s7 offen nt
  s_add_u32 s7, s7, 8192
  buffer_load_dwordx4 v[220:223], v2, s[56:59], s7 offen nt
  v_lshrrev_b32 v3, 4, v1
  v_lshlrev_b32 v4, 6, v3
  v_and_b32 v3, 3, v1
  v_lshl_add_u32 v4, v3, 4, v4
  v_bfe_u32 v3, v1, 2, 1
  v_mul_u32_u24 v2, 9216, v3
  v_add_u32 v2, v2, v4
  s_and_b32 s12, s4, 15
  s_mul_i32 s12, s12, 18432
  s_lshr_b32 s13, s4, 4
  s_mul_i32 s13, s13, 768
  s_add_u32 s12, s12, s13
  v_add_u32 v2, s12, v2
  v_bfe_u32 v3, v1, 2, 2
  v_mul_u32_u24 v3, 768, v3
  v_add_u32 v3, v3, v4
  s_lshr_b32 s12, s4, 1
  s_add_u32 s12, s12, 32
  s_mul_i32 s12, s12, 9216
  v_add_u32 v3, s12, v3
  s_mov_b32 s60, 0x10000
  s_mov_b32 s61, 0x11800
  s_mov_b32 s15, 0x400000
L_pg_3:
  buffer_load_dwordx4 v[16:19], v2, s[44:47], s60 offen offset:0 sc1
  buffer_load_dwordx4 v[20:23], v2, s[44:47], s60 offen offset:256 sc1
  buffer_load_dwordx4 v[24:27], v2, s[44:47], s60 offen offset:512 sc1
  buffer_load_dwordx4 v[28:31], v2, s[44:47], s60 offen offset:3072 sc1
  buffer_load_dwordx4 v[32:35], v2, s[44:47], s60 offen offset:3328 sc1
  buffer_load_dwordx4 v[36:39], v2, s[44:47], s60 offen offset:3584 sc1
  buffer_load_dwordx4 v[40:43], v2, s[44:47], s61 offen offset:0 sc1
  buffer_load_dwordx4 v[44:47], v2, s[44:47], s61 offen offset:256 sc1
  buffer_load_dwordx4 v[48:51], v2, s[44:47], s61 offen offset:512 sc1
  buffer_load_dwordx4 v[52:55], v3, s[44:47], s60 offen offset:0 sc1
  buffer_load_dwordx4 v[56:59], v3, s[44:47], s60 offen offset:256 sc1
  buffer_load_dwordx4 v[60:63], v3, s[44:47], s60 offen offset:512 sc1
  buffer_load_dwordx4 v[64:67], v3, s[44:47], s60 offen offset:3072 sc1
  buffer_load_dwordx4 v[68:71], v3, s[44:47], s60 offen offset:3328 sc1
  buffer_load_dwordx4 v[72:75], v3, s[44:47], s60 offen offset:3584 sc1
  buffer_load_dwordx4 v[76:79], v3, s[44:47], s61 offen offset:0 sc1
  buffer_load_dwordx4 v[80:83], v3, s[44:47], s61 offen offset:256 sc1
  buffer_load_dwordx4 v[84:87], v3, s[44:47], s61 offen offset:512 sc1
  s_waitcnt vmcnt(0)
  v_and_b32 v88, v19, v23
  v_or_b32 v89, v19, v23
  v_and_b32 v88, v88, v27
  v_and_b32 v88, v88, v31
  v_and_b32 v88, v88, v35
  v_and_b32 v88, v88, v39
  v_and_b32 v88, v88, v43
  v_and_b32 v88, v88, v47
  v_and_b32 v88, v88, v51
  v_and_b32 v88, v88, v55
  v_and_b32 v88, v88, v59
  v_and_b32 v88, v88, v63
  v_and_b32 v88, v88, v67
  v_and_b32 v88, v88, v71
  v_and_b32 v88, v88, v75
  v_and_b32 v88, v88, v79
  v_and_b32 v88, v88, v83
  v_and_b32 v88, v88, v87
  v_or3_b32 v89, v89, v27, v31
  v_or3_b32 v89, v89, v35, v39
  v_or3_b32 v89, v89, v43, v47
  v_or3_b32 v89, v89, v51, v55
  v_or3_b32 v89, v89, v59, v63
  v_or3_b32 v89, v89, v67, v71
  v_or3_b32 v89, v89, v75, v79
  v_or3_b32 v89, v89, v83, v87
  v_xor_b32 v88, s6, v88
  v_xor_b32 v89, s6, v89
  v_or_b32 v88, v88, v89
  v_cmp_ne_u32 vcc, 0, v88
  s_nop 4
  s_cbranch_vccz L_pgd_4
  s_mov_b64 exec, vcc
  s_sleep 8
  s_sub_u32 s15, s15, 1
  s_mov_b32 s14, 11
  s_cmp_eq_u32 s15, 0
  s_cbranch_scc1 L_fail
  s_branch L_pg_3
L_pgd_4:
  s_mov_b64 exec, -1
  v_add_f32 v16, v16, v28
  v_add_f32 v17, v17, v29
  v_add_f32 v18, v18, v30
  v_add_f32 v20, v20, v32
  v_add_f32 v21, v21, v33
  v_add_f32 v22, v22, v34
  v_add_f32 v24, v24, v36
  v_add_f32 v25, v25, v37
  v_add_f32 v16, v16, v40
  v_add_f32 v17, v17, v41
  v_add_f32 v18, v18, v42
  v_add_f32 v20, v20, v44
  v_add_f32 v21, v21, v45
  v_add_f32 v22, v22, v46
  v_add_f32 v24, v24, v48
  v_add_f32 v25, v25, v49
  v_cvt_pk_bf16_f32 v4, v16, v17
  v_cvt_pk_bf16_f32 v5, v18, v20
  v_cvt_pk_bf16_f32 v6, v21, v22
  v_cvt_pk_bf16_f32 v7, v24, v25
  v_add_f32 v52, v52, v64
  v_add_f32 v53, v53, v65
  v_add_f32 v54, v54, v66
  v_add_f32 v56, v56, v68
  v_add_f32 v57, v57, v69
  v_add_f32 v58, v58, v70
  v_add_f32 v60, v60, v72
  v_add_f32 v61, v61, v73
  v_add_f32 v52, v52, v76
  v_add_f32 v53, v53, v77
  v_add_f32 v54, v54, v78
  v_add_f32 v56, v56, v80
  v_add_f32 v57, v57, v81
  v_add_f32 v58, v58, v82
  v_add_f32 v60, v60, v84
  v_add_f32 v61, v61, v85
  v_cvt_pk_bf16_f32 v92, v52, v53
  v_cvt_pk_bf16_f32 v93, v54, v56
  v_cvt_pk_bf16_f32 v94, v57, v58
  v_cvt_pk_bf16_f32 v95, v60, v61
  s_mov_b32 s62, 0xff00ff00
  s_mov_b32 s63, 0xff00ff00
  v_cndmask_b32 v8, v4, 0, s[62:63]
  v_cndmask_b32 v12, 0, v4, s[62:63]
  v_cndmask_b32 v9, v5, 0, s[62:63]
  v_cndmask_b32 v13, 0, v5, s[62:63]
  v_cndmask_b32 v10, v6, 0, s[62:63]
  v_cndmask_b32 v14, 0, v6, s[62:63]
  v_cndmask_b32 v11, v7, 0, s[62:63]
  v_cndmask_b32 v15, 0, v7, s[62:63]
  v_lshlrev_b32 v2, 4, v1
  ds_write_b128 v2, v[8:11] offset:256
  ds_write_b128 v2, v[12:15] offset:1280
  v_mov_b32 v2, 4
  v_mov_b32 v3, 1
  s_mov_b64 exec, 1
  ds_write_b32 v2, v3
  s_mov_b64 exec, -1
  v_bfe_u32 v3, v1, 2, 2
  v_lshlrev_b32 v2, 16, v3
  v_lshrrev_b32 v3, 4, v1
  v_lshl_add_u32 v2, v3, 9, v2
  v_and_b32 v3, 1, v1
  v_lshl_add_u32 v2, v3, 4, v2
  s_lshr_b32 s13, s4, 1
  s_lshr_b32 s7, s13, 4
  s_lshl_b32 s7, s7, 15
  s_lshl_b32 s12, s69, 11
  s_add_u32 s7, s7, s12
  s_and_b32 s12, s13, 15
  s_lshl_b32 s12, s12, 5
  s_add_u32 s7, s7, s12
  s_add_u32 s7, s7, 0x280000
  s_add_u32 s12, s7, 4096
  s_cmp_lt_u32 s5, 2
  s_cselect_b32 s12, s12, 0x40000000
  s_mov_b32 vcc_lo, 0xaaaaaaaa
  s_mov_b32 vcc_hi, 0xaaaaaaaa
  v_mfma_f32_16x16x32_bf16 v[16:19], v[128:131], v[92:95], 0
  v_mfma_f32_16x16x32_bf16 v[20:23], v[132:135], v[92:95], 0
  v_mfma_f32_16x16x32_bf16 v[24:27], v[136:139], v[92:95], 0
  v_mfma_f32_16x16x32_bf16 v[28:31], v[140:143], v[92:95], 0
  v_mfma_f32_16x16x32_bf16 v[32:35], v[144:147], v[92:95], 0
  v_mfma_f32_16x16x32_bf16 v[36:39], v[148:151], v[92:95], 0
  v_mfma_f32_16x16x32_bf16 v[40:43], v[152:155], v[92:95], 0
  v_mfma_f32_16x16x32_bf16 v[44:47], v[156:159], v[92:95], 0
  v_mfma_f32_16x16x32_bf16 v[48:51], v[160:163], v[92:95], 0
  v_mfma_f32_16x16x32_bf16 v[52:55], v[164:167], v[92:95], 0
  v_mfma_f32_16x16x32_bf16 v[56:59], v[168:171], v[92:95], 0
  v_mfma_f32_16x16x32_bf16 v[60:63], v[172:175], v[92:95], 0
  v_mfma_f32_16x16x32_bf16 v[64:67], v[176:179], v[92:95], 0
  v_mfma_f32_16x16x32_bf16 v[68:71], v[180:183], v[92:95], 0
  v_mfma_f32_16x16x32_bf16 v[72:75], v[184:187], v[92:95], 0
  v_mfma_f32_16x16x32_bf16 v[76:79], v[188:191], v[92:95], 0
  v_mfma_f32_16x16x32_bf16 v[96:99], v[192:195], v[92:95], 0
  v_mfma_f32_16x16x32_bf16 v[100:103], v[196:199], v[92:95], 0
  v_mfma_f32_16x16x32_bf16 v[104:107], v[200:203], v[92:95], 0
  v_mfma_f32_16x16x32_bf16 v[108:111], v[204:207], v[92:95], 0
  v_mfma_f32_16x16x32_bf16 v[112:115], v[208:211], v[92:95], 0
  v_mfma_f32_16x16x32_bf16 v[116:119], v[212:215], v[92:95], 0
  v_mfma_f32_16x16x32_bf16 v[120:123], v[216:219], v[92:95], 0
  v_mfma_f32_16x16x32_bf16 v[124:127], v[220:223], v[92:95], 0
  v_mov_b32_dpp v4, v16 quad_perm:[0,0,0,0] row_mask:0xf bank_mask:0xf
  v_mov_b32_dpp v5, v20 quad_perm:[0,0,0,0] row_mask:0xf bank_mask:0xf
  v_mov_b32_dpp v6, v24 quad_perm:[0,0,0,0] row_mask:0xf bank_mask:0xf
  v_mov_b32_dpp v7, v28 quad_perm:[0,0,0,0] row_mask:0xf bank_mask:0xf
  v_mov_b32_dpp v8, v32 quad_perm:[0,0,0,0] row_mask:0xf bank_mask:0xf
  v_mov_b32_dpp v9, v36 quad_perm:[0,0,0,0] row_mask:0xf bank_mask:0xf
  v_mov_b32_dpp v10, v40 quad_perm:[0,0,0,0] row_mask:0xf bank_mask:0xf
  v_mov_b32_dpp v11, v44 quad_perm:[0,0,0,0] row_mask:0xf bank_mask:0xf
  v_add_f32_dpp v4, v17, v4 quad_perm:[1,1,1,1] row_mask:0xf bank_mask:0xf
  v_add_f32_dpp v5, v21, v5 quad_perm:[1,1,1,1] row_mask:0xf bank_mask:0xf
  v_add_f32_dpp v6, v25, v6 quad_perm:[1,1,1,1] row_mask:0xf bank_mask:0xf
  v_add_f32_dpp v7, v29, v7 quad_perm:[1,1,1,1] row_mask:0xf bank_mask:0xf
  v_add_f32_dpp v8, v33, v8 quad_perm:[1,1,1,1] row_mask:0xf bank_mask:0xf
  v_add_f32_dpp v9, v37, v9 quad_perm:[1,1,1,1] row_mask:0xf bank_mask:0xf
  v_add_f32_dpp v10, v41, v10 quad_perm:[1,1,1,1] row_mask:0xf bank_mask:0xf
  v_add_f32_dpp v11, v45, v11 quad_perm:[1,1,1,1] row_mask:0xf bank_mask:0xf
  v_add_f32_dpp v4, v18, v4 quad_perm:[2,2,2,2] row_mask:0xf bank_mask:0xf
  v_add_f32_dpp v5, v22, v5 quad_perm:[2,2,2,2] row_mask:0xf bank_mask:0xf
  v_add_f32_dpp v6, v26, v6 quad_perm:[2,2,2,2] row_mask:0xf bank_mask:0xf
  v_add_f32_dpp v7, v30, v7 quad_perm:[2,2,2,2] row_mask:0xf bank_mask:0xf
  v_add_f32_dpp v8, v34, v8 quad_perm:[2,2,2,2] row_mask:0xf bank_mask:0xf
  v_add_f32_dpp v9, v38, v9 quad_perm:[2,2,2,2] row_mask:0xf bank_mask:0xf
  v_add_f32_dpp v10, v42, v10 quad_perm:[2,2,2,2] row_mask:0xf bank_mask:0xf
  v_add_f32_dpp v11, v46, v11 quad_perm:[2,2,2,2] row_mask:0xf bank_mask:0xf
  v_add_f32_dpp v4, v19, v4 quad_perm:[3,3,3,3] row_mask:0xf bank_mask:0xf
  v_add_f32_dpp v5, v23, v5 quad_perm:[3,3,3,3] row_mask:0xf bank_mask:0xf
  v_add_f32_dpp v6, v27, v6 quad_perm:[3,3,3,3] row_mask:0xf bank_mask:0xf
  v_add_f32_dpp v7, v31, v7 quad_perm:[3,3,3,3] row_mask:0xf bank_mask:0xf
  v_add_f32_dpp v8, v35, v8 quad_perm:[3,3,3,3] row_mask:0xf bank_mask:0xf
  v_add_f32_dpp v9, v39, v9 quad_perm:[3,3,3,3] row_mask:0xf bank_mask:0xf
  v_add_f32_dpp v10, v43, v10 quad_perm:[3,3,3,3] row_mask:0xf bank_mask:0xf
  v_add_f32_dpp v11, v47, v11 quad_perm:[3,3,3,3] row_mask:0xf bank_mask:0xf
  v_cvt_pk_bf16_f32 v12, v4, v5
  v_cvt_pk_bf16_f32 v13, v6, v7
  v_cvt_pk_bf16_f32 v14, v8, v9
  v_cvt_pk_bf16_f32 v15, v10, v11
  v_cndmask_b32 v224, v12, v14, vcc
  v_cndmask_b32 v225, v13, v15, vcc
  v_mov_b32 v226, s6
  v_mov_b32 v227, s6
  s_mov_b32 exec_lo, 0x33333333
  s_mov_b32 exec_hi, 0x33333333
  buffer_store_dwordx4 v[224:227], v2, s[44:47], s7 offen offset:0 sc1
  s_mov_b64 exec, -1
  v_mov_b32_dpp v4, v48 quad_perm:[0,0,0,0] row_mask:0xf bank_mask:0xf
  v_mov_b32_dpp v5, v52 quad_perm:[0,0,0,0] row_mask:0xf bank_mask:0xf
  v_mov_b32_dpp v6, v56 quad_perm:[0,0,0,0] row_mask:0xf bank_mask:0xf
  v_mov_b32_dpp v7, v60 quad_perm:[0,0,0,0] row_mask:0xf bank_mask:0xf
  v_mov_b32_dpp v8, v64 quad_perm:[0,0,0,0] row_mask:0xf bank_mask:0xf
  v_mov_b32_dpp v9, v68 quad_perm:[0,0,0,0] row_mask:0xf bank_mask:0xf
  v_mov_b32_dpp v10, v72 quad_perm:[0,0,0,0] row_mask:0xf bank_mask:0xf
  v_mov_b32_dpp v11, v76 quad_perm:[0,0,0,0] row_mask:0xf bank_mask:0xf
  v_add_f32_dpp v4, v49, v4 quad_perm:[1,1,1,1] row_mask:0xf bank_mask:0xf
  v_add_f32_dpp v5, v53, v5 quad_perm:[1,1,1,1] row_mask:0xf bank_mask:0xf
  v_add_f32_dpp v6, v57, v6 quad_perm:[1,1,1,1] row_mask:0xf bank_mask:0xf
  v_add_f32_dpp v7, v61, v7 quad_perm:[1,1,1,1] row_mask:0xf bank_mask:0xf
  v_add_f32_dpp v8, v65, v8 quad_perm:[1,1,1,1] row_mask:0xf bank_mask:0xf
  v_add_f32_dpp v9, v69, v9 quad_perm:[1,1,1,1] row_mask:0xf bank_mask:0xf
  v_add_f32_dpp v10, v73, v10 quad_perm:[1,1,1,1] row_mask:0xf bank_mask:0xf
  v_add_f32_dpp v11, v77, v11 quad_perm:[1,1,1,1] row_mask:0xf bank_mask:0xf
  v_add_f32_dpp v4, v50, v4 quad_perm:[2,2,2,2] row_mask:0xf bank_mask:0xf
  v_add_f32_dpp v5, v54, v5 quad_perm:[2,2,2,2] row_mask:0xf bank_mask:0xf
  v_add_f32_dpp v6, v58, v6 quad_perm:[2,2,2,2] row_mask:0xf bank_mask:0xf
  v_add_f32_dpp v7, v62, v7 quad_perm:[2,2,2,2] row_mask:0xf bank_mask:0xf
  v_add_f32_dpp v8, v66, v8 quad_perm:[2,2,2,2] row_mask:0xf bank_mask:0xf
  v_add_f32_dpp v9, v70, v9 quad_perm:[2,2,2,2] row_mask:0xf bank_mask:0xf
  v_add_f32_dpp v10, v74, v10 quad_perm:[2,2,2,2] row_mask:0xf bank_mask:0xf
  v_add_f32_dpp v11, v78, v11 quad_perm:[2,2,2,2] row_mask:0xf bank_mask:0xf
  v_add_f32_dpp v4, v51, v4 quad_perm:[3,3,3,3] row_mask:0xf bank_mask:0xf
  v_add_f32_dpp v5, v55, v5 quad_perm:[3,3,3,3] row_mask:0xf bank_mask:0xf
  v_add_f32_dpp v6, v59, v6 quad_perm:[3,3,3,3] row_mask:0xf bank_mask:0xf
  v_add_f32_dpp v7, v63, v7 quad_perm:[3,3,3,3] row_mask:0xf bank_mask:0xf
  v_add_f32_dpp v8, v67, v8 quad_perm:[3,3,3,3] row_mask:0xf bank_mask:0xf
  v_add_f32_dpp v9, v71, v9 quad_perm:[3,3,3,3] row_mask:0xf bank_mask:0xf
  v_add_f32_dpp v10, v75, v10 quad_perm:[3,3,3,3] row_mask:0xf bank_mask:0xf
  v_add_f32_dpp v11, v79, v11 quad_perm:[3,3,3,3] row_mask:0xf bank_mask:0xf
  v_cvt_pk_bf16_f32 v12, v4, v5
  v_cvt_pk_bf16_f32 v13, v6, v7
  v_cvt_pk_bf16_f32 v14, v8, v9
  v_cvt_pk_bf16_f32 v15, v10, v11
  v_cndmask_b32 v228, v12, v14, vcc
  v_cndmask_b32 v229, v13, v15, vcc
  v_mov_b32 v230, s6
  v_mov_b32 v231, s6
  s_mov_b32 exec_lo, 0x33333333
  s_mov_b32 exec_hi, 0x33333333
  buffer_store_dwordx4 v[228:231], v2, s[44:47], s7 offen offset:2048 sc1
  s_mov_b64 exec, -1
  v_mov_b32_dpp v4, v96 quad_perm:[0,0,0,0] row_mask:0xf bank_mask:0xf
  v_mov_b32_dpp v5, v100 quad_perm:[0,0,0,0] row_mask:0xf bank_mask:0xf
  v_mov_b32_dpp v6, v104 quad_perm:[0,0,0,0] row_mask:0xf bank_mask:0xf
  v_mov_b32_dpp v7, v108 quad_perm:[0,0,0,0] row_mask:0xf bank_mask:0xf
  v_mov_b32_dpp v8, v112 quad_perm:[0,0,0,0] row_mask:0xf bank_mask:0xf
  v_mov_b32_dpp v9, v116 quad_perm:[0,0,0,0] row_mask:0xf bank_mask:0xf
  v_mov_b32_dpp v10, v120 quad_perm:[0,0,0,0] row_mask:0xf bank_mask:0xf
  v_mov_b32_dpp v11, v124 quad_perm:[0,0,0,0] row_mask:0xf bank_mask:0xf
  v_add_f32_dpp v4, v97, v4 quad_perm:[1,1,1,1] row_mask:0xf bank_mask:0xf
  v_add_f32_dpp v5, v101, v5 quad_perm:[1,1,1,1] row_mask:0xf bank_mask:0xf
  v_add_f32_dpp v6, v105, v6 quad_perm:[1,1,1,1] row_mask:0xf bank_mask:0xf
  v_add_f32_dpp v7, v109, v7 quad_perm:[1,1,1,1] row_mask:0xf bank_mask:0xf
  v_add_f32_dpp v8, v113, v8 quad_perm:[1,1,1,1] row_mask:0xf bank_mask:0xf
  v_add_f32_dpp v9, v117, v9 quad_perm:[1,1,1,1] row_mask:0xf bank_mask:0xf
  v_add_f32_dpp v10, v121, v10 quad_perm:[1,1,1,1] row_mask:0xf bank_mask:0xf
  v_add_f32_dpp v11, v125, v11 quad_perm:[1,1,1,1] row_mask:0xf bank_mask:0xf
  v_add_f32_dpp v4, v98, v4 quad_perm:[2,2,2,2] row_mask:0xf bank_mask:0xf
  v_add_f32_dpp v5, v102, v5 quad_perm:[2,2,2,2] row_mask:0xf bank_mask:0xf
  v_add_f32_dpp v6, v106, v6 quad_perm:[2,2,2,2] row_mask:0xf bank_mask:0xf
  v_add_f32_dpp v7, v110, v7 quad_perm:[2,2,2,2] row_mask:0xf bank_mask:0xf
  v_add_f32_dpp v8, v114, v8 quad_perm:[2,2,2,2] row_mask:0xf bank_mask:0xf
  v_add_f32_dpp v9, v118, v9 quad_perm:[2,2,2,2] row_mask:0xf bank_mask:0xf
  v_add_f32_dpp v10, v122, v10 quad_perm:[2,2,2,2] row_mask:0xf bank_mask:0xf
  v_add_f32_dpp v11, v126, v11 quad_perm:[2,2,2,2] row_mask:0xf bank_mask:0xf
  v_add_f32_dpp v4, v99, v4 quad_perm:[3,3,3,3] row_mask:0xf bank_mask:0xf
  v_add_f32_dpp v5, v103, v5 quad_perm:[3,3,3,3] row_mask:0xf bank_mask:0xf
  v_add_f32_dpp v6, v107, v6 quad_perm:[3,3,3,3] row_mask:0xf bank_mask:0xf
  v_add_f32_dpp v7, v111, v7 quad_perm:[3,3,3,3] row_mask:0xf bank_mask:0xf
  v_add_f32_dpp v8, v115, v8 quad_perm:[3,3,3,3] row_mask:0xf bank_mask:0xf
  v_add_f32_dpp v9, v119, v9 quad_perm:[3,3,3,3] row_mask:0xf bank_mask:0xf
  v_add_f32_dpp v10, v123, v10 quad_perm:[3,3,3,3] row_mask:0xf bank_mask:0xf
  v_add_f32_dpp v11, v127, v11 quad_perm:[3,3,3,3] row_mask:0xf bank_mask:0xf
  v_cvt_pk_bf16_f32 v12, v4, v5
  v_cvt_pk_bf16_f32 v13, v6, v7
  v_cvt_pk_bf16_f32 v14, v8, v9
  v_cvt_pk_bf16_f32 v15, v10, v11
  v_cndmask_b32 v232, v12, v14, vcc
  v_cndmask_b32 v233, v13, v15, vcc
  v_mov_b32 v234, s6
  v_mov_b32 v235, s6
  s_mov_b32 exec_lo, 0x33333333
  s_mov_b32 exec_hi, 0x33333333
  buffer_store_dwordx4 v[232:235], v2, s[44:47], s12 offen offset:0 sc1
  s_mov_b64 exec, -1
  s_nop 0
  s_branch L_astart
L_s47:
  s_cmp_lg_u32 s3, 4
  s_cbranch_scc1 L_sb_5
  v_lshlrev_b32 v2, 2, v1
  v_mov_b32 v3, 0
  ds_write_b32 v2, v3
  s_nop 0
L_sb_5:
  s_waitcnt lgkmcnt(0)
  s_load_dword s6, s[42:43], 0
  s_mov_b32 s44, s42
  s_mov_b32 s45, s43
  s_mov_b32 s46, 0x10000000
  s_mov_b32 s47, 0x20000
L_astart:
  s_mov_b32 s48, s18
  s_mov_b32 s49, s19
  s_mov_b32 s50, 0x4000000
  s_mov_b32 s51, 0x20000
  s_mov_b32 s52, s20
  s_mov_b32 s53, s21
  s_mov_b32 s54, 0x4000000
  s_mov_b32 s55, 0x20000
  v_bfe_u32 v4, v1, 2, 2
  v_lshlrev_b32 v2, 8, v4
  v_lshrrev_b32 v4, 4, v1
  v_lshl_add_u32 v2, v4, 6, v2
  v_and_b32 v4, 3, v1
  v_lshl_add_u32 v2, v4, 4, v2
  v_lshlrev_b32 v3, 4, v1
  s_lshl_b32 s62, s4, 20
  s_mul_i32 s67, s4, 16384
  s_mul_i32 s12, s5, 180224
  s_add_u32 s63, s67, s12
  s_add_u32 s67, s67, 540672
  s_mov_b32 s66, 0
  s_cmp_lt_u32 s3, 4
  s_cbranch_scc1 L_pro03
  s_mov_b32 s69, 7
  s_lshl_b32 s60, s11, 13
  s_add_u32 s60, s60, s63
  s_and_b32 s60, s60, 0xfffff
  s_add_u32 s60, s60, s62
  s_add_u32 s61, s60, 4096
  s_waitcnt lgkmcnt(0)
  s_add_u32 s6, s6, 0x9e3779b9
  s_barrier
  buffer_load_dwordx4 v[64:67], v2, s[48:51], s60 offen offset:0 nt
  buffer_load_dwordx4 v[68:71], v2, s[48:51], s60 offen offset:1024 nt
  buffer_load_dwordx4 v[72:75], v2, s[48:51], s60 offen offset:2048 nt
  buffer_load_dwordx4 v[76:79], v2, s[48:51], s60 offen offset:3072 nt
  buffer_load_dwordx4 v[80:83], v2, s[48:51], s61 offen offset:0 nt
  s_waitcnt vmcnt(4)
  buffer_load_dwordx4 v[84:87], v2, s[48:51], s61 offen offset:1024 nt
  s_waitcnt vmcnt(4)
  buffer_load_dwordx4 v[88:91], v2, s[48:51], s61 offen offset:2048 nt
  s_waitcnt vmcnt(4)
  buffer_load_dwordx4 v[92:95], v2, s[48:51], s61 offen offset:3072 nt
  s_waitcnt vmcnt(4)
  buffer_load_dwordx4 v[96:99], v3, s[52:55], s60 offen offset:0 nt
  s_waitcnt vmcnt(4)
  buffer_load_dwordx4 v[100:103], v3, s[52:55], s60 offen offset:1024 nt
  s_waitcnt vmcnt(4)
  buffer_load_dwordx4 v[104:107], v3, s[52:55], s60 offen offset:2048 nt
  s_waitcnt vmcnt(4)
  buffer_load_dwordx4 v[108:111], v3, s[52:55], s60 offen offset:3072 nt
  s_waitcnt vmcnt(4)
  buffer_load_dwordx4 v[112:115], v3, s[52:55], s61 offen offset:0 nt
  s_waitcnt vmcnt(4)
  buffer_load_dwordx4 v[116:119], v3, s[52:55], s61 offen offset:1024 nt
  s_waitcnt vmcnt(4)
  buffer_load_dwordx4 v[120:123], v3, s[52:55], s61 offen offset:2048 nt
  s_waitcnt vmcnt(4)
  buffer_load_dwordx4 v[124:127], v3, s[52:55], s61 offen offset:3072 nt
  s_lshl_b32 s60, s11, 13
  s_add_u32 s60, s60, s63
  s_add_u32 s60, s60, 32768
  s_and_b32 s60, s60, 0xfffff
  s_add_u32 s60, s60, s62
  s_add_u32 s61, s60, 4096
  s_waitcnt vmcnt(4)
  buffer_load_dwordx4 v[128:131], v2, s[48:51], s60 offen offset:0 nt
  s_waitcnt vmcnt(4)
  buffer_load_dwordx4 v[132:135], v2, s[48:51], s60 offen offset:1024 nt
  s_waitcnt vmcnt(4)
  buffer_load_dwordx4 v[136:139], v2, s[48:51], s60 offen offset:2048 nt
  s_waitcnt vmcnt(4)
  buffer_load_dwordx4 v[140:143], v2, s[48:51], s60 offen offset:3072 nt
  s_waitcnt vmcnt(4)
  buffer_load_dwordx4 v[144:147], v2, s[48:51], s61 offen offset:0 nt
  s_waitcnt vmcnt(4)
  buffer_load_dwordx4 v[148:151], v2, s[48:51], s61 offen offset:1024 nt
  s_waitcnt vmcnt(4)
  buffer_load_dwordx4 v[152:155], v2, s[48:51], s61 offen offset:2048 nt
  s_waitcnt vmcnt(4)
  buffer_load_dwordx4 v[156:159], v2, s[48:51], s61 offen offset:3072 nt
  s_waitcnt vmcnt(4)
  buffer_load_dwordx4 v[160:163], v3, s[52:55], s60 offen offset:0 nt
  s_waitcnt vmcnt(4)
  buffer_load_dwordx4 v[164:167], v3, s[52:55], s60 offen offset:1024 nt
  s_waitcnt vmcnt(4)
  buffer_load_dwordx4 v[168:171], v3, s[52:55], s60 offen offset:2048 nt
  s_waitcnt vmcnt(4)
  buffer_load_dwordx4 v[172:175], v3, s[52:55], s60 offen offset:3072 nt
  s_waitcnt vmcnt(4)
  buffer_load_dwordx4 v[176:179], v3, s[52:55], s61 offen offset:0 nt
  s_waitcnt vmcnt(4)
  buffer_load_dwordx4 v[180:183], v3, s[52:55], s61 offen offset:1024 nt
  s_waitcnt vmcnt(4)
  buffer_load_dwordx4 v[184:187], v3, s[52:55], s61 offen offset:2048 nt
  s_waitcnt vmcnt(4)
  buffer_load_dwordx4 v[188:191], v3, s[52:55], s61 offen offset:3072 nt
L_proend0:
  s_branch L_prodone
L_pro03:
  s_setprio 0
  s_mov_b32 s69, 0
  v_mov_b32 v23, 20
  v_mov_b32 v22, 1
  s_mov_b64 exec, 1
  ds_add_rtn_u32 v22, v23, v22
  s_waitcnt lgkmcnt(0)
  v_readfirstlane_b32 s12, v22
  s_mov_b64 exec, -1
  s_add_u32 s12, s12, 8
  s_lshl_b32 s60, s12, 13
  s_add_u32 s60, s60, s63
  s_and_b32 s60, s60, 0xfffff
  s_add_u32 s60, s60, s62
  s_cmp_lt_u32 s12, 22
  s_cselect_b32 s13, 1, 0
  s_cselect_b32 s60, s60, 0x40000000
  s_or_b32 s69, s69, s13
  s_add_u32 s61, s60, 4096
  buffer_load_dwordx4 v[64:67], v2, s[48:51], s60 offen offset:0 nt
  buffer_load_dwordx4 v[68:71], v2, s[48:51], s60 offen offset:1024 nt
  buffer_load_dwordx4 v[72:75], v2, s[48:51], s60 offen offset:2048 nt
  buffer_load_dwordx4 v[76:79], v2, s[48:51], s60 offen offset:3072 nt
  buffer_load_dwordx4 v[80:83], v2, s[48:51], s61 offen offset:0 nt
  s_waitcnt vmcnt(4)
  buffer_load_dwordx4 v[84:87], v2, s[48:51], s61 offen offset:1024 nt
  s_waitcnt vmcnt(4)
  buffer_load_dwordx4 v[88:91], v2, s[48:51], s61 offen offset:2048 nt
  s_waitcnt vmcnt(4)
  buffer_load_dwordx4 v[92:95], v2, s[48:51], s61 offen offset:3072 nt
  s_waitcnt vmcnt(4)
  buffer_load_dwordx4 v[96:99], v3, s[52:55], s60 offen offset:0 nt
  s_waitcnt vmcnt(4)
  buffer_load_dwordx4 v[100:103], v3, s[52:55], s60 offen offset:1024 nt
  s_waitcnt vmcnt(4)
  buffer_load_dwordx4 v[104:107], v3, s[52:55], s60 offen offset:2048 nt
  s_waitcnt vmcnt(4)
  buffer_load_dwordx4 v[108:111], v3, s[52:55], s60 offen offset:3072 nt
  s_waitcnt vmcnt(4)
  buffer_load_dwordx4 v[112:115], v3, s[52:55], s61 offen offset:0 nt
  s_waitcnt vmcnt(4)
  buffer_load_dwordx4 v[116:119], v3, s[52:55], s61 offen offset:1024 nt
  s_waitcnt vmcnt(4)
  buffer_load_dwordx4 v[120:123], v3, s[52:55], s61 offen offset:2048 nt
  s_waitcnt vmcnt(4)
  buffer_load_dwordx4 v[124:127], v3, s[52:55], s61 offen offset:3072 nt
  v_mov_b32 v23, 20
  v_mov_b32 v22, 1
  s_mov_b64 exec, 1
  ds_add_rtn_u32 v22, v23, v22
  s_waitcnt lgkmcnt(0)
  v_readfirstlane_b32 s12, v22
  s_mov_b64 exec, -1
  s_add_u32 s12, s12, 8
  s_lshl_b32 s60, s12, 13
  s_add_u32 s60, s60, s63
  s_and_b32 s60, s60, 0xfffff
  s_add_u32 s60, s60, s62
  s_cmp_lt_u32 s12, 22
  s_cselect_b32 s13, 2, 0
  s_cselect_b32 s60, s60, 0x40000000
  s_or_b32 s69, s69, s13
  s_add_u32 s61, s60, 4096
  s_waitcnt vmcnt(4)
  buffer_load_dwordx4 v[128:131], v2, s[48:51], s60 offen offset:0 nt
  s_waitcnt vmcnt(4)
  buffer_load_dwordx4 v[132:135], v2, s[48:51], s60 offen offset:1024 nt
  s_waitcnt vmcnt(4)
  buffer_load_dwordx4 v[136:139], v2, s[48:51], s60 offen offset:2048 nt
  s_waitcnt vmcnt(4)
  buffer_load_dwordx4 v[140:143], v2, s[48:51], s60 offen offset:3072 nt
  s_waitcnt vmcnt(4)
  buffer_load_dwordx4 v[144:147], v2, s[48:51], s61 offen offset:0 nt
  s_waitcnt vmcnt(4)
  buffer_load_dwordx4 v[148:151], v2, s[48:51], s61 offen offset:1024 nt
  s_waitcnt vmcnt(4)
  buffer_load_dwordx4 v[152:155], v2, s[48:51], s61 offen offset:2048 nt
  s_waitcnt vmcnt(4)
  buffer_load_dwordx4 v[156:159], v2, s[48:51], s61 offen offset:3072 nt
  s_waitcnt vmcnt(4)
  buffer_load_dwordx4 v[160:163], v3, s[52:55], s60 offen offset:0 nt
  s_waitcnt vmcnt(4)
  buffer_load_dwordx4 v[164:167], v3, s[52:55], s60 offen offset:1024 nt
  s_waitcnt vmcnt(4)
  buffer_load_dwordx4 v[168:171], v3, s[52:55], s60 offen offset:2048 nt
  s_waitcnt vmcnt(4)
  buffer_load_dwordx4 v[172:175], v3, s[52:55], s60 offen offset:3072 nt
  s_waitcnt vmcnt(4)
  buffer_load_dwordx4 v[176:179], v3, s[52:55], s61 offen offset:0 nt
  s_waitcnt vmcnt(4)
  buffer_load_dwordx4 v[180:183], v3, s[52:55], s61 offen offset:1024 nt
  s_waitcnt vmcnt(4)
  buffer_load_dwordx4 v[184:187], v3, s[52:55], s61 offen offset:2048 nt
  s_waitcnt vmcnt(4)
  buffer_load_dwordx4 v[188:191], v3, s[52:55], s61 offen offset:3072 nt
L_proend1:
L_prodone:
  v_bfe_u32 v24, v1, 3, 1
  v_lshlrev_b32 v24, 1, v24
  v_bfe_u32 v25, v1, 1, 1
  v_add_u32 v24, v24, v25
  v_and_b32 v25, 1, v1
  v_lshlrev_b32 v25, 4, v25
  v_mov_b32 v26, 0xffff
  v_lshlrev_b32 v25, v25, v26
  v_cmp_eq_u32 vcc, 0, v24
  s_nop 1
  v_cndmask_b32 v4, 0, v25, vcc
  v_cmp_eq_u32 vcc, 1, v24
  s_nop 1
  v_cndmask_b32 v5, 0, v25, vcc
  v_cmp_eq_u32 vcc, 2, v24
  s_nop 1
  v_cndmask_b32 v6, 0, v25, vcc
  v_cmp_eq_u32 vcc, 3, v24
  s_nop 1
  v_cndmask_b32 v7, 0, v25, vcc
  s_mov_b32 s64, 0x0f0ff0f0
  s_mov_b32 s65, 0x0f0ff0f0
  v_mov_b32 v16, 0
  v_mov_b32 v17, 0
  v_mov_b32 v18, 0
  v_mov_b32 v19, 0
  v_mov_b32 v20, 0xff7fffff
  v_mov_b32 v21, 0
  v_mov_b32 v25, 4
  s_mov_b32 s15, 0x4000000
  s_nop 0
L_lw_6:
  ds_read_b32 v24, v25
  s_waitcnt lgkmcnt(0)
  v_readfirstlane_b32 s7, v24
  s_nop 0
  s_cmp_ge_u32 s7, 1
  s_nop 2
  s_cbranch_scc1 L_lwd_7
  s_sleep 2
  s_sub_u32 s15, s15, 1
  s_mov_b32 s14, 20
  s_cmp_eq_u32 s15, 0
  s_cbranch_scc1 L_fail
  s_branch L_lw_6
L_lwd_7:
  v_lshlrev_b32 v24, 4, v1
  ds_read_b128 v[8:11], v24 offset:256
  ds_read_b128 v[12:15], v24 offset:1280
  s_waitcnt lgkmcnt(0)
  v_bfe_u32 v26, v1, 4, 1
  v_lshlrev_b32 v197, 9, v26
  v_and_b32 v25, 15, v1
  v_lshl_add_u32 v197, v25, 5, v197
  v_mul_u32_u24 v199, 12288, v26
  v_lshl_add_u32 v199, v25, 4, v199
  v_lshrrev_b32 v25, 5, v1
  v_lshl_add_u32 v196, v25, 4, v197
  s_lshl_b32 s7, s3, 10
  v_add_u32 v196, s7, v196
  s_lshl_b32 s7, s3, 3
  v_lshlrev_b32 v198, 4, v1
  v_add_u32 v198, s7, v198
  s_and_b32 s12, s4, 15
  s_mul_i32 s12, s12, 24576
  s_lshr_b32 s13, s4, 4
  s_lshl_b32 s13, s13, 2
  s_add_u32 s13, s13, s5
  s_mul_i32 s13, s13, 768
  s_add_u32 s12, s12, s13
  s_add_u32 s97, s12, 0xd0000
  s_lshl_b32 s12, s4, 8
  s_add_u32 s12, s12, 0x4000
  v_mov_b32 v194, s12
  v_mov_b32 v192, 0
  v_mov_b32 v193, 0
  s_setprio 1
  s_cmp_lt_u32 s3, 6
  s_cbranch_scc1 L_aloop
  s_setprio 0
  s_mov_b32 s66, 1
  v_mov_b32 v192, 1
  s_mov_b64 exec, 1
  buffer_atomic_add v192, v194, s[44:47], 0 offen sc0 sc1
  s_mov_b64 exec, -1
  v_mov_b32 v193, 1
  s_mov_b64 exec, 1
  buffer_atomic_add v193, v194, s[44:47], 0 offen sc0 sc1
  s_mov_b64 exec, -1
  s_waitcnt vmcnt(0)
L_aloop:
  s_bitcmp1_b32 s69, 0
  s_cbranch_scc0 L_alast
  s_bitcmp1_b32 s69, 1
  s_cbranch_scc0 L_ff_9
  s_cmp_eq_u32 s66, 1
  s_cbranch_scc1 L_fp_8
  v_mov_b32 v23, 20
  v_mov_b32 v22, 1
  s_mov_b64 exec, 1
  ds_add_rtn_u32 v22, v23, v22
  s_waitcnt lgkmcnt(0)
  v_readfirstlane_b32 s12, v22
  s_mov_b64 exec, -1
  s_add_u32 s12, s12, 8
  s_lshl_b32 s60, s12, 13
  s_add_u32 s60, s60, s63
  s_and_b32 s60, s60, 0xfffff
  s_add_u32 s60, s60, s62
  s_cmp_lt_u32 s12, 22
  s_branch L_ff_9
L_fp_8:
  s_waitcnt vmcnt(32)
  v_readfirstlane_b32 s12, v192
  s_nop 0
  s_cmp_lt_u32 s12, 62
  s_nop 2
  s_cbranch_scc1 L_tv_11
  s_waitcnt vmcnt(16)
  v_readfirstlane_b32 s13, v193
  v_mov_b32 v193, s12
  s_mov_b32 s12, s13
  s_nop 2
L_tv_11:
  s_lshl_b32 s60, s12, 13
  s_add_u32 s60, s60, s67
  s_and_b32 s60, s60, 0xfffff
  s_add_u32 s60, s60, s62
  s_cmp_lt_u32 s12, 62
L_ff_9:
  s_cselect_b32 s60, s60, 0x40000000
  s_cselect_b64 s[98:99], -1, 1
  s_cselect_b32 s13, 0, 1
  s_cselect_b32 s12, s3, 0
  s_andn2_b32 s69, s69, s13
  s_add_u32 s61, s60, 4096
  s_cmp_lt_u32 s12, 6
  s_cbranch_scc1 L_fn_10
  v_mov_b32 v192, 1
  s_mov_b64 exec, 1
  buffer_atomic_add v192, v194, s[44:47], 0 offen sc0 sc1
  s_mov_b64 exec, -1
L_fn_10:
  s_waitcnt vmcnt(31)
  v_mfma_f32_16x16x32_bf16 v[24:27], v[64:67], v[8:11], 0
  s_mov_b64 exec, s[98:99]
  buffer_load_dwordx4 v[64:67], v2, s[48:51], s60 offen offset:0 nt
  s_mov_b64 exec, -1
  s_waitcnt vmcnt(31)
  v_mfma_f32_16x16x32_bf16 v[24:27], v[68:71], v[12:15], v[24:27]
  s_mov_b64 exec, s[98:99]
  buffer_load_dwordx4 v[68:71], v2, s[48:51], s60 offen offset:1024 nt
  s_mov_b64 exec, -1
  s_waitcnt vmcnt(31)
  v_mfma_f32_16x16x32_bf16 v[28:31], v[72:75], v[8:11], 0
  s_mov_b64 exec, s[98:99]
  buffer_load_dwordx4 v[72:75], v2, s[48:51], s60 offen offset:2048 nt
  s_mov_b64 exec, -1
  s_waitcnt vmcnt(31)
  v_mfma_f32_16x16x32_bf16 v[28:31], v[76:79], v[12:15], v[28:31]
  s_mov_b64 exec, s[98:99]
  buffer_load_dwordx4 v[76:79], v2, s[48:51], s60 offen offset:3072 nt
  s_mov_b64 exec, -1
  s_waitcnt vmcnt(31)
  v_mfma_f32_16x16x32_bf16 v[32:35], v[80:83], v[8:11], 0
  s_mov_b64 exec, s[98:99]
  buffer_load_dwordx4 v[80:83], v2, s[48:51], s61 offen offset:0 nt
  s_mov_b64 exec, -1
  s_waitcnt vmcnt(31)
  v_mfma_f32_16x16x32_bf16 v[32:35], v[84:87], v[12:15], v[32:35]
  s_mov_b64 exec, s[98:99]
  buffer_load_dwordx4 v[84:87], v2, s[48:51], s61 offen offset:1024 nt
  s_mov_b64 exec, -1
  s_waitcnt vmcnt(31)
  v_mfma_f32_16x16x32_bf16 v[36:39], v[88:91], v[8:11], 0
  s_mov_b64 exec, s[98:99]
  buffer_load_dwordx4 v[88:91], v2, s[48:51], s61 offen offset:2048 nt
  s_mov_b64 exec, -1
  s_waitcnt vmcnt(31)
  v_mfma_f32_16x16x32_bf16 v[36:39], v[92:95], v[12:15], v[36:39]
  s_mov_b64 exec, s[98:99]
  buffer_load_dwordx4 v[92:95], v2, s[48:51], s61 offen offset:3072 nt
  s_mov_b64 exec, -1
  v_mov_b32_dpp v40, v24 quad_perm:[0,0,0,0] row_mask:0xf bank_mask:0xf
  v_mov_b32_dpp v41, v28 quad_perm:[0,0,0,0] row_mask:0xf bank_mask:0xf
  v_mov_b32_dpp v42, v32 quad_perm:[0,0,0,0] row_mask:0xf bank_mask:0xf
  s_nop 1
  v_mov_b32_dpp v43, v36 quad_perm:[0,0,0,0] row_mask:0xf bank_mask:0xf
  v_add_f32_dpp v40, v25, v40 quad_perm:[1,1,1,1] row_mask:0xf bank_mask:0xf
  v_add_f32_dpp v41, v29, v41 quad_perm:[1,1,1,1] row_mask:0xf bank_mask:0xf
  v_add_f32_dpp v42, v33, v42 quad_perm:[1,1,1,1] row_mask:0xf bank_mask:0xf
  v_add_f32_dpp v43, v37, v43 quad_perm:[1,1,1,1] row_mask:0xf bank_mask:0xf
  v_add_f32_dpp v40, v26, v40 quad_perm:[2,2,2,2] row_mask:0xf bank_mask:0xf
  v_add_f32_dpp v41, v30, v41 quad_perm:[2,2,2,2] row_mask:0xf bank_mask:0xf
  v_add_f32_dpp v42, v34, v42 quad_perm:[2,2,2,2] row_mask:0xf bank_mask:0xf
  v_add_f32_dpp v43, v38, v43 quad_perm:[2,2,2,2] row_mask:0xf bank_mask:0xf
  v_add_f32_dpp v40, v27, v40 quad_perm:[3,3,3,3] row_mask:0xf bank_mask:0xf
  v_add_f32_dpp v41, v31, v41 quad_perm:[3,3,3,3] row_mask:0xf bank_mask:0xf
  v_add_f32_dpp v42, v35, v42 quad_perm:[3,3,3,3] row_mask:0xf bank_mask:0xf
  v_add_f32_dpp v43, v39, v43 quad_perm:[3,3,3,3] row_mask:0xf bank_mask:0xf
  v_max3_f32 v22, v40, v41, v42
  v_max3_f32 v22, v22, v43, v20
  s_nop 1
  v_max_f32_dpp v22, v22, v22 row_ror:8 row_mask:0xf bank_mask:0xf
  v_mov_b32 v23, v22
  s_nop 1
  v_permlane16_swap_b32 v22, v23
  v_max_f32 v22, v22, v23
  v_mov_b32 v23, v22
  s_nop 1
  v_permlane32_swap_b32 v22, v23
  v_max_f32 v22, v22, v23
  v_sub_f32 v23, v20, v22
  v_mul_f32 v23, s10, v23
  v_exp_f32 v23, v23
  v_mov_b32 v20, v22
  v_mul_f32 v22, s10, v22
  v_fma_f32 v40, v40, s10, -v22
  v_fma_f32 v41, v41, s10, -v22
  v_fma_f32 v42, v42, s10, -v22
  v_fma_f32 v43, v43, s10, -v22
  v_exp_f32 v40, v40
  v_exp_f32 v41, v41
  v_exp_f32 v42, v42
  v_exp_f32 v43, v43
  v_mov_b32_dpp v22, v23 row_ror:4 row_mask:0xf bank_mask:0xf
  v_cvt_pk_bf16_f32 v44, v40, v40
  v_cvt_pk_bf16_f32 v45, v41, v41
  v_cvt_pk_bf16_f32 v46, v42, v42
  v_cvt_pk_bf16_f32 v47, v43, v43
  v_cndmask_b32 v22, v23, v22, s[64:65]
  v_add_f32 v40, v40, v41
  v_add_f32 v42, v42, v43
  v_add_f32 v40, v40, v42
  v_fma_f32 v21, v21, v23, v40
  v_mul_f32 v16, v16, v22
  v_mul_f32 v17, v17, v22
  v_mul_f32 v18, v18, v22
  v_mul_f32 v19, v19, v22
  v_and_b32 v48, v44, v4
  v_and_b32 v49, v44, v5
  v_and_b32_dpp v50, v44, v6 row_ror:8 row_mask:0xf bank_mask:0xf
  v_and_b32_dpp v51, v44, v7 row_ror:8 row_mask:0xf bank_mask:0xf
  v_and_b32_dpp v52, v44, v4 row_ror:8 row_mask:0xf bank_mask:0xf
  v_and_b32_dpp v53, v44, v5 row_ror:8 row_mask:0xf bank_mask:0xf
  v_and_b32 v54, v44, v6
  v_and_b32 v55, v44, v7
  s_waitcnt vmcnt(31)
  v_mfma_f32_16x16x32_bf16 v[16:19], v[48:51], v[96:99], v[16:19]
  s_mov_b64 exec, s[98:99]
  buffer_load_dwordx4 v[96:99], v3, s[52:55], s60 offen offset:0 nt
  s_mov_b64 exec, -1
  s_waitcnt vmcnt(31)
  v_mfma_f32_16x16x32_bf16 v[16:19], v[52:55], v[100:103], v[16:19]
  s_mov_b64 exec, s[98:99]
  buffer_load_dwordx4 v[100:103], v3, s[52:55], s60 offen offset:1024 nt
  s_mov_b64 exec, -1
  v_and_b32 v56, v45, v4
  v_and_b32 v57, v45, v5
  v_and_b32_dpp v58, v45, v6 row_ror:8 row_mask:0xf bank_mask:0xf
  v_and_b32_dpp v59, v45, v7 row_ror:8 row_mask:0xf bank_mask:0xf
  v_and_b32_dpp v60, v45, v4 row_ror:8 row_mask:0xf bank_mask:0xf
  v_and_b32_dpp v61, v45, v5 row_ror:8 row_mask:0xf bank_mask:0xf
  v_and_b32 v62, v45, v6
  v_and_b32 v63, v45, v7
  s_waitcnt vmcnt(31)
  v_mfma_f32_16x16x32_bf16 v[16:19], v[56:59], v[104:107], v[16:19]
  s_mov_b64 exec, s[98:99]
  buffer_load_dwordx4 v[104:107], v3, s[52:55], s60 offen offset:2048 nt
  s_mov_b64 exec, -1
  s_waitcnt vmcnt(31)
  v_mfma_f32_16x16x32_bf16 v[16:19], v[60:63], v[108:111], v[16:19]
  s_mov_b64 exec, s[98:99]
  buffer_load_dwordx4 v[108:111], v3, s[52:55], s60 offen offset:3072 nt
  s_mov_b64 exec, -1
  v_and_b32 v48, v46, v4
  v_and_b32 v49, v46, v5
  v_and_b32_dpp v50, v46, v6 row_ror:8 row_mask:0xf bank_mask:0xf
  v_and_b32_dpp v51, v46, v7 row_ror:8 row_mask:0xf bank_mask:0xf
  v_and_b32_dpp v52, v46, v4 row_ror:8 row_mask:0xf bank_mask:0xf
  v_and_b32_dpp v53, v46, v5 row_ror:8 row_mask:0xf bank_mask:0xf
  v_and_b32 v54, v46, v6
  v_and_b32 v55, v46, v7
  s_waitcnt vmcnt(31)
  v_mfma_f32_16x16x32_bf16 v[16:19], v[48:51], v[112:115], v[16:19]
  s_mov_b64 exec, s[98:99]
  buffer_load_dwordx4 v[112:115], v3, s[52:55], s61 offen offset:0 nt
  s_mov_b64 exec, -1
  s_waitcnt vmcnt(31)
  v_mfma_f32_16x16x32_bf16 v[16:19], v[52:55], v[116:119], v[16:19]
  s_mov_b64 exec, s[98:99]
  buffer_load_dwordx4 v[116:119], v3, s[52:55], s61 offen offset:1024 nt
  s_mov_b64 exec, -1
  v_and_b32 v56, v47, v4
  v_and_b32 v57, v47, v5
  v_and_b32_dpp v58, v47, v6 row_ror:8 row_mask:0xf bank_mask:0xf
  v_and_b32_dpp v59, v47, v7 row_ror:8 row_mask:0xf bank_mask:0xf
  v_and_b32_dpp v60, v47, v4 row_ror:8 row_mask:0xf bank_mask:0xf
  v_and_b32_dpp v61, v47, v5 row_ror:8 row_mask:0xf bank_mask:0xf
  v_and_b32 v62, v47, v6
  v_and_b32 v63, v47, v7
  s_waitcnt vmcnt(31)
  v_mfma_f32_16x16x32_bf16 v[16:19], v[56:59], v[120:123], v[16:19]
  s_mov_b64 exec, s[98:99]
  buffer_load_dwordx4 v[120:123], v3, s[52:55], s61 offen offset:2048 nt
  s_mov_b64 exec, -1
  s_waitcnt vmcnt(31)
  v_mfma_f32_16x16x32_bf16 v[16:19], v[60:63], v[124:127], v[16:19]
  s_mov_b64 exec, s[98:99]
  buffer_load_dwordx4 v[124:127], v3, s[52:55], s61 offen offset:3072 nt
  s_mov_b64 exec, -1
  s_bitcmp1_b32 s69, 1
  s_nop 3
  s_cbranch_scc0 L_alast
  s_bitcmp1_b32 s69, 0
  s_cbranch_scc0 L_ff_13
  s_cmp_eq_u32 s66, 1
  s_cbranch_scc1 L_fp_12
  v_mov_b32 v23, 20
  v_mov_b32 v22, 1
  s_mov_b64 exec, 1
  ds_add_rtn_u32 v22, v23, v22
  s_waitcnt lgkmcnt(0)
  v_readfirstlane_b32 s12, v22
  s_mov_b64 exec, -1
  s_add_u32 s12, s12, 8
  s_lshl_b32 s60, s12, 13
  s_add_u32 s60, s60, s63
  s_and_b32 s60, s60, 0xfffff
  s_add_u32 s60, s60, s62
  s_cmp_lt_u32 s12, 22
  s_branch L_ff_13
L_fp_12:
  s_waitcnt vmcnt(32)
  v_readfirstlane_b32 s12, v193
  s_nop 0
  s_cmp_lt_u32 s12, 62
  s_nop 2
  s_cbranch_scc1 L_tv_15
  s_waitcnt vmcnt(16)
  v_readfirstlane_b32 s13, v192
  v_mov_b32 v192, s12
  s_mov_b32 s12, s13
  s_nop 2
L_tv_15:
  s_lshl_b32 s60, s12, 13
  s_add_u32 s60, s60, s67
  s_and_b32 s60, s60, 0xfffff
  s_add_u32 s60, s60, s62
  s_cmp_lt_u32 s12, 62
L_ff_13:
  s_cselect_b32 s60, s60, 0x40000000
  s_cselect_b64 s[98:99], -1, 1
  s_cselect_b32 s13, 0, 2
  s_cselect_b32 s12, s3, 0
  s_andn2_b32 s69, s69, s13
  s_add_u32 s61, s60, 4096
  s_cmp_lt_u32 s12, 6
  s_cbranch_scc1 L_fn_14
  v_mov_b32 v193, 1
  s_mov_b64 exec, 1
  buffer_atomic_add v193, v194, s[44:47], 0 offen sc0 sc1
  s_mov_b64 exec, -1
L_fn_14:
  s_waitcnt vmcnt(31)
  v_mfma_f32_16x16x32_bf16 v[24:27], v[128:131], v[8:11], 0
  s_mov_b64 exec, s[98:99]
  buffer_load_dwordx4 v[128:131], v2, s[48:51], s60 offen offset:0 nt
  s_mov_b64 exec, -1
  s_waitcnt vmcnt(31)
  v_mfma_f32_16x16x32_bf16 v[24:27], v[132:135], v[12:15], v[24:27]
  s_mov_b64 exec, s[98:99]
  buffer_load_dwordx4 v[132:135], v2, s[48:51], s60 offen offset:1024 nt
  s_mov_b64 exec, -1
  s_waitcnt vmcnt(31)
  v_mfma_f32_16x16x32_bf16 v[28:31], v[136:139], v[8:11], 0
  s_mov_b64 exec, s[98:99]
  buffer_load_dwordx4 v[136:139], v2, s[48:51], s60 offen offset:2048 nt
  s_mov_b64 exec, -1
  s_waitcnt vmcnt(31)
  v_mfma_f32_16x16x32_bf16 v[28:31], v[140:143], v[12:15], v[28:31]
  s_mov_b64 exec, s[98:99]
  buffer_load_dwordx4 v[140:143], v2, s[48:51], s60 offen offset:3072 nt
  s_mov_b64 exec, -1
  s_waitcnt vmcnt(31)
  v_mfma_f32_16x16x32_bf16 v[32:35], v[144:147], v[8:11], 0
  s_mov_b64 exec, s[98:99]
  buffer_load_dwordx4 v[144:147], v2, s[48:51], s61 offen offset:0 nt
  s_mov_b64 exec, -1
  s_waitcnt vmcnt(31)
  v_mfma_f32_16x16x32_bf16 v[32:35], v[148:151], v[12:15], v[32:35]
  s_mov_b64 exec, s[98:99]
  buffer_load_dwordx4 v[148:151], v2, s[48:51], s61 offen offset:1024 nt
  s_mov_b64 exec, -1
  s_waitcnt vmcnt(31)
  v_mfma_f32_16x16x32_bf16 v[36:39], v[152:155], v[8:11], 0
  s_mov_b64 exec, s[98:99]
  buffer_load_dwordx4 v[152:155], v2, s[48:51], s61 offen offset:2048 nt
  s_mov_b64 exec, -1
  s_waitcnt vmcnt(31)
  v_mfma_f32_16x16x32_bf16 v[36:39], v[156:159], v[12:15], v[36:39]
  s_mov_b64 exec, s[98:99]
  buffer_load_dwordx4 v[156:159], v2, s[48:51], s61 offen offset:3072 nt
  s_mov_b64 exec, -1
  v_mov_b32_dpp v40, v24 quad_perm:[0,0,0,0] row_mask:0xf bank_mask:0xf
  v_mov_b32_dpp v41, v28 quad_perm:[0,0,0,0] row_mask:0xf bank_mask:0xf
  v_mov_b32_dpp v42, v32 quad_perm:[0,0,0,0] row_mask:0xf bank_mask:0xf
  s_nop 1
  v_mov_b32_dpp v43, v36 quad_perm:[0,0,0,0] row_mask:0xf bank_mask:0xf
  v_add_f32_dpp v40, v25, v40 quad_perm:[1,1,1,1] row_mask:0xf bank_mask:0xf
  v_add_f32_dpp v41, v29, v41 quad_perm:[1,1,1,1] row_mask:0xf bank_mask:0xf
  v_add_f32_dpp v42, v33, v42 quad_perm:[1,1,1,1] row_mask:0xf bank_mask:0xf
  v_add_f32_dpp v43, v37, v43 quad_perm:[1,1,1,1] row_mask:0xf bank_mask:0xf
  v_add_f32_dpp v40, v26, v40 quad_perm:[2,2,2,2] row_mask:0xf bank_mask:0xf
  v_add_f32_dpp v41, v30, v41 quad_perm:[2,2,2,2] row_mask:0xf bank_mask:0xf
  v_add_f32_dpp v42, v34, v42 quad_perm:[2,2,2,2] row_mask:0xf bank_mask:0xf
  v_add_f32_dpp v43, v38, v43 quad_perm:[2,2,2,2] row_mask:0xf bank_mask:0xf
  v_add_f32_dpp v40, v27, v40 quad_perm:[3,3,3,3] row_mask:0xf bank_mask:0xf
  v_add_f32_dpp v41, v31, v41 quad_perm:[3,3,3,3] row_mask:0xf bank_mask:0xf
  v_add_f32_dpp v42, v35, v42 quad_perm:[3,3,3,3] row_mask:0xf bank_mask:0xf
  v_add_f32_dpp v43, v39, v43 quad_perm:[3,3,3,3] row_mask:0xf bank_mask:0xf
  v_max3_f32 v22, v40, v41, v42
  v_max3_f32 v22, v22, v43, v20
  s_nop 1
  v_max_f32_dpp v22, v22, v22 row_ror:8 row_mask:0xf bank_mask:0xf
  v_mov_b32 v23, v22
  s_nop 1
  v_permlane16_swap_b32 v22, v23
  v_max_f32 v22, v22, v23
  v_mov_b32 v23, v22
  s_nop 1
  v_permlane32_swap_b32 v22, v23
  v_max_f32 v22, v22, v23
  v_sub_f32 v23, v20, v22
  v_mul_f32 v23, s10, v23
  v_exp_f32 v23, v23
  v_mov_b32 v20, v22
  v_mul_f32 v22, s10, v22
  v_fma_f32 v40, v40, s10, -v22
  v_fma_f32 v41, v41, s10, -v22
  v_fma_f32 v42, v42, s10, -v22
  v_fma_f32 v43, v43, s10, -v22
  v_exp_f32 v40, v40
  v_exp_f32 v41, v41
  v_exp_f32 v42, v42
  v_exp_f32 v43, v43
  v_mov_b32_dpp v22, v23 row_ror:4 row_mask:0xf bank_mask:0xf
  v_cvt_pk_bf16_f32 v44, v40, v40
  v_cvt_pk_bf16_f32 v45, v41, v41
  v_cvt_pk_bf16_f32 v46, v42, v42
  v_cvt_pk_bf16_f32 v47, v43, v43
  v_cndmask_b32 v22, v23, v22, s[64:65]
  v_add_f32 v40, v40, v41
  v_add_f32 v42, v42, v43
  v_add_f32 v40, v40, v42
  v_fma_f32 v21, v21, v23, v40
  v_mul_f32 v16, v16, v22
  v_mul_f32 v17, v17, v22
  v_mul_f32 v18, v18, v22
  v_mul_f32 v19, v19, v22
  v_and_b32 v48, v44, v4
  v_and_b32 v49, v44, v5
  v_and_b32_dpp v50, v44, v6 row_ror:8 row_mask:0xf bank_mask:0xf
  v_and_b32_dpp v51, v44, v7 row_ror:8 row_mask:0xf bank_mask:0xf
  v_and_b32_dpp v52, v44, v4 row_ror:8 row_mask:0xf bank_mask:0xf
  v_and_b32_dpp v53, v44, v5 row_ror:8 row_mask:0xf bank_mask:0xf
  v_and_b32 v54, v44, v6
  v_and_b32 v55, v44, v7
  s_waitcnt vmcnt(31)
  v_mfma_f32_16x16x32_bf16 v[16:19], v[48:51], v[160:163], v[16:19]
  s_mov_b64 exec, s[98:99]
  buffer_load_dwordx4 v[160:163], v3, s[52:55], s60 offen offset:0 nt
  s_mov_b64 exec, -1
  s_waitcnt vmcnt(31)
  v_mfma_f32_16x16x32_bf16 v[16:19], v[52:55], v[164:167], v[16:19]
  s_mov_b64 exec, s[98:99]
  buffer_load_dwordx4 v[164:167], v3, s[52:55], s60 offen offset:1024 nt
  s_mov_b64 exec, -1
  v_and_b32 v56, v45, v4
  v_and_b32 v57, v45, v5
  v_and_b32_dpp v58, v45, v6 row_ror:8 row_mask:0xf bank_mask:0xf
  v_and_b32_dpp v59, v45, v7 row_ror:8 row_mask:0xf bank_mask:0xf
  v_and_b32_dpp v60, v45, v4 row_ror:8 row_mask:0xf bank_mask:0xf
  v_and_b32_dpp v61, v45, v5 row_ror:8 row_mask:0xf bank_mask:0xf
  v_and_b32 v62, v45, v6
  v_and_b32 v63, v45, v7
  s_waitcnt vmcnt(31)
  v_mfma_f32_16x16x32_bf16 v[16:19], v[56:59], v[168:171], v[16:19]
  s_mov_b64 exec, s[98:99]
  buffer_load_dwordx4 v[168:171], v3, s[52:55], s60 offen offset:2048 nt
  s_mov_b64 exec, -1
  s_waitcnt vmcnt(31)
  v_mfma_f32_16x16x32_bf16 v[16:19], v[60:63], v[172:175], v[16:19]
  s_mov_b64 exec, s[98:99]
  buffer_load_dwordx4 v[172:175], v3, s[52:55], s60 offen offset:3072 nt
  s_mov_b64 exec, -1
  v_and_b32 v48, v46, v4
  v_and_b32 v49, v46, v5
  v_and_b32_dpp v50, v46, v6 row_ror:8 row_mask:0xf bank_mask:0xf
  v_and_b32_dpp v51, v46, v7 row_ror:8 row_mask:0xf bank_mask:0xf
  v_and_b32_dpp v52, v46, v4 row_ror:8 row_mask:0xf bank_mask:0xf
  v_and_b32_dpp v53, v46, v5 row_ror:8 row_mask:0xf bank_mask:0xf
  v_and_b32 v54, v46, v6
  v_and_b32 v55, v46, v7
  s_waitcnt vmcnt(31)
  v_mfma_f32_16x16x32_bf16 v[16:19], v[48:51], v[176:179], v[16:19]
  s_mov_b64 exec, s[98:99]
  buffer_load_dwordx4 v[176:179], v3, s[52:55], s61 offen offset:0 nt
  s_mov_b64 exec, -1
  s_waitcnt vmcnt(31)
  v_mfma_f32_16x16x32_bf16 v[16:19], v[52:55], v[180:183], v[16:19]
  s_mov_b64 exec, s[98:99]
  buffer_load_dwordx4 v[180:183], v3, s[52:55], s61 offen offset:1024 nt
  s_mov_b64 exec, -1
  v_and_b32 v56, v47, v4
  v_and_b32 v57, v47, v5
  v_and_b32_dpp v58, v47, v6 row_ror:8 row_mask:0xf bank_mask:0xf
  v_and_b32_dpp v59, v47, v7 row_ror:8 row_mask:0xf bank_mask:0xf
  v_and_b32_dpp v60, v47, v4 row_ror:8 row_mask:0xf bank_mask:0xf
  v_and_b32_dpp v61, v47, v5 row_ror:8 row_mask:0xf bank_mask:0xf
  v_and_b32 v62, v47, v6
  v_and_b32 v63, v47, v7
  s_waitcnt vmcnt(31)
  v_mfma_f32_16x16x32_bf16 v[16:19], v[56:59], v[184:187], v[16:19]
  s_mov_b64 exec, s[98:99]
  buffer_load_dwordx4 v[184:187], v3, s[52:55], s61 offen offset:2048 nt
  s_mov_b64 exec, -1
  s_waitcnt vmcnt(31)
  v_mfma_f32_16x16x32_bf16 v[16:19], v[60:63], v[188:191], v[16:19]
  s_mov_b64 exec, s[98:99]
  buffer_load_dwordx4 v[188:191], v3, s[52:55], s61 offen offset:3072 nt
  s_mov_b64 exec, -1
  s_nop 4
  s_branch L_aloop
L_alast:
  v_add_f32_dpp v21, v21, v21 row_ror:8 row_mask:0xf bank_mask:0xf
  v_mov_b32 v23, v21
  s_nop 1
  v_permlane16_swap_b32 v21, v23
  v_add_f32 v21, v21, v23
  v_mov_b32 v23, v21
  s_nop 1
  v_permlane32_swap_b32 v21, v23
  v_add_f32 v21, v21, v23
  ds_write_b128 v196, v[16:19] offset:3328
  s_cmp_lt_u32 s3, 6
  s_cselect_b32 s7, 16, 12
  v_mov_b32 v26, 1
  v_mov_b32 v27, s7
  v_mov_b32 v24, 1
  v_mov_b32 v28, 8
  s_mov_b64 exec, 17
  ds_write_b64 v198, v[20:21] offset:11520
  s_mov_b64 exec, 1
  ds_add_rtn_u32 v26, v27, v26
  ds_add_u32 v28, v24
  s_mov_b64 exec, -1
  v_bfe_u32 v25, v1, 4, 1
  v_lshlrev_b32 v25, 6, v25
  v_mov_b32 v63, s6
  s_waitcnt lgkmcnt(1)
  v_readfirstlane_b32 s12, v26
  s_cmp_ge_u32 s3, 6
  s_nop 3
  s_cbranch_scc1 L_lv2_17
  s_cmp_lg_u32 s12, 5
  s_cbranch_scc1 L_afin_16
  ds_read_b128 v[28:31], v25 offset:11520
  ds_read_b128 v[32:35], v25 offset:11536
  ds_read_b128 v[36:39], v25 offset:11552
  ds_read_b128 v[200:203], v197 offset:3328
  ds_read_b128 v[204:207], v197 offset:3344
  ds_read_b128 v[208:211], v197 offset:4352
  ds_read_b128 v[212:215], v197 offset:4368
  ds_read_b128 v[216:219], v197 offset:5376
  ds_read_b128 v[220:223], v197 offset:5392
  ds_read_b128 v[224:227], v197 offset:6400
  ds_read_b128 v[228:231], v197 offset:6416
  ds_read_b128 v[232:235], v197 offset:7424
  ds_read_b128 v[236:239], v197 offset:7440
  ds_read_b128 v[240:243], v197 offset:8448
  ds_read_b128 v[244:247], v197 offset:8464
  s_waitcnt lgkmcnt(0)
  v_max3_f32 v40, v28, v30, v32
  v_max3_f32 v27, v34, v36, v38
  v_max_f32 v40, v40, v27
  v_mul_f32 v26, s10, v40
  v_fma_f32 v28, v28, s10, -v26
  v_fma_f32 v30, v30, s10, -v26
  v_fma_f32 v32, v32, s10, -v26
  v_fma_f32 v34, v34, s10, -v26
  v_fma_f32 v36, v36, s10, -v26
  v_fma_f32 v38, v38, s10, -v26
  v_exp_f32 v28, v28
  v_exp_f32 v30, v30
  v_exp_f32 v32, v32
  v_exp_f32 v34, v34
  v_exp_f32 v36, v36
  v_exp_f32 v38, v38
  v_mul_f32 v41, v28, v29
  v_fmac_f32 v41, v30, v31
  v_fmac_f32 v41, v32, v33
  v_fmac_f32 v41, v34, v35
  v_fmac_f32 v41, v36, v37
  v_fmac_f32 v41, v38, v39
  v_mul_f32 v4, v200, v28
  v_mul_f32 v5, v201, v28
  v_mul_f32 v6, v202, v28
  v_mul_f32 v7, v203, v28
  v_mul_f32 v8, v204, v28
  v_mul_f32 v9, v205, v28
  v_mul_f32 v10, v206, v28
  v_mul_f32 v11, v207, v28
  v_fmac_f32 v4, v208, v30
  v_fmac_f32 v5, v209, v30
  v_fmac_f32 v6, v210, v30
  v_fmac_f32 v7, v211, v30
  v_fmac_f32 v8, v212, v30
  v_fmac_f32 v9, v213, v30
  v_fmac_f32 v10, v214, v30
  v_fmac_f32 v11, v215, v30
  v_fmac_f32 v4, v216, v32
  v_fmac_f32 v5, v217, v32
  v_fmac_f32 v6, v218, v32
  v_fmac_f32 v7, v219, v32
  v_fmac_f32 v8, v220, v32
  v_fmac_f32 v9, v221, v32
  v_fmac_f32 v10, v222, v32
  v_fmac_f32 v11, v223, v32
  v_fmac_f32 v4, v224, v34
  v_fmac_f32 v5, v225, v34
  v_fmac_f32 v6, v226, v34
  v_fmac_f32 v7, v227, v34
  v_fmac_f32 v8, v228, v34
  v_fmac_f32 v9, v229, v34
  v_fmac_f32 v10, v230, v34
  v_fmac_f32 v11, v231, v34
  v_fmac_f32 v4, v232, v36
  v_fmac_f32 v5, v233, v36
  v_fmac_f32 v6, v234, v36
  v_fmac_f32 v7, v235, v36
  v_fmac_f32 v8, v236, v36
  v_fmac_f32 v9, v237, v36
  v_fmac_f32 v10, v238, v36
  v_fmac_f32 v11, v239, v36
  v_fmac_f32 v4, v240, v38
  v_fmac_f32 v5, v241, v38
  v_fmac_f32 v6, v242, v38
  v_fmac_f32 v7, v243, v38
  v_fmac_f32 v8, v244, v38
  v_fmac_f32 v9, v245, v38
  v_fmac_f32 v10, v246, v38
  v_fmac_f32 v11, v247, v38
  s_mov_b32 exec_hi, 0
  ds_write_b128 v197, v[4:7] offset:8448
  ds_write_b128 v197, v[8:11] offset:8464
  s_mov_b64 exec, 0x10001
  ds_write_b64 v25, v[40:41] offset:11560
  v_mov_b32 v26, 1
  v_mov_b32 v27, 12
  s_mov_b64 exec, 1
  ds_add_rtn_u32 v26, v27, v26
  s_mov_b64 exec, -1
  s_waitcnt lgkmcnt(0)
  v_readfirstlane_b32 s12, v26
  s_nop 4
L_lv2_17:
  s_cmp_eq_u32 s12, 1
  s_cbranch_scc1 L_afin_16
  s_cmp_eq_u32 s12, 0
  s_cselect_b32 s97, 0x40000000, s97
  ds_read_b64 v[30:31], v25 offset:11560
  ds_read_b128 v[32:35], v25 offset:11568
  ds_read_b128 v[200:203], v197 offset:8448
  ds_read_b128 v[204:207], v197 offset:8464
  ds_read_b128 v[208:211], v197 offset:9472
  ds_read_b128 v[212:215], v197 offset:9488
  ds_read_b128 v[216:219], v197 offset:10496
  ds_read_b128 v[220:223], v197 offset:10512
  v_mov_b32 v23, s6
  v_mov_b32 v19, s6
  s_waitcnt lgkmcnt(6)
  v_max3_f32 v26, v30, v32, v34
  v_mul_f32 v26, s10, v26
  v_fma_f32 v30, v30, s10, -v26
  v_fma_f32 v32, v32, s10, -v26
  v_fma_f32 v34, v34, s10, -v26
  v_exp_f32 v30, v30
  v_exp_f32 v32, v32
  v_exp_f32 v34, v34
  v_mul_f32 v27, v30, v31
  v_fmac_f32 v27, v32, v33
  v_fmac_f32 v27, v34, v35
  v_rcp_f32 v12, v27
  v_log_f32 v13, v27
  s_waitcnt lgkmcnt(4)
  v_mul_f32 v16, v200, v30
  v_mul_f32 v17, v201, v30
  v_mul_f32 v18, v202, v30
  v_mul_f32 v20, v203, v30
  v_mul_f32 v21, v204, v30
  v_mul_f32 v22, v205, v30
  v_mul_f32 v60, v206, v30
  v_mul_f32 v61, v207, v30
  s_waitcnt lgkmcnt(2)
  v_fmac_f32 v16, v208, v32
  v_fmac_f32 v17, v209, v32
  v_fmac_f32 v18, v210, v32
  v_fmac_f32 v20, v211, v32
  v_fmac_f32 v21, v212, v32
  v_fmac_f32 v22, v213, v32
  v_fmac_f32 v60, v214, v32
  v_fmac_f32 v61, v215, v32
  s_waitcnt lgkmcnt(0)
  v_fmac_f32 v16, v216, v34
  v_fmac_f32 v17, v217, v34
  v_fmac_f32 v18, v218, v34
  v_fmac_f32 v20, v219, v34
  v_fmac_f32 v21, v220, v34
  v_fmac_f32 v22, v221, v34
  v_fmac_f32 v60, v222, v34
  v_fmac_f32 v61, v223, v34
  v_add_f32 v62, v26, v13
  v_mul_f32 v16, v16, v12
  v_mul_f32 v17, v17, v12
  v_mul_f32 v18, v18, v12
  v_mul_f32 v20, v20, v12
  v_mul_f32 v21, v21, v12
  v_mul_f32 v22, v22, v12
  v_mul_f32 v60, v60, v12
  v_mul_f32 v61, v61, v12
  s_mov_b32 exec_hi, 0
  buffer_store_dwordx4 v[16:19], v199, s[44:47], s97 offen sc1
  buffer_store_dwordx4 v[20:23], v199, s[44:47], s97 offen offset:256 sc1
  buffer_store_dwordx4 v[60:63], v199, s[44:47], s97 offen offset:512 sc1
  s_mov_b64 exec, -1
  s_nop 0
L_afin_16:
  s_mov_b32 s96, 0
  s_cmp_ge_u32 s3, 4
  s_cbranch_scc1 L_endw
  s_cmp_lg_u32 s5, 0
  s_cbranch_scc1 L_anf_18
  s_cmp_eq_u32 s96, 0
  s_cselect_b32 s56, s24, s36
  s_cselect_b32 s57, s25, s37
  s_mov_b32 s58, 4718592
  s_mov_b32 s59, 0x20000
  s_lshr_b32 s7, s4, 1
  s_lshl_b32 s7, s7, 2
  s_add_u32 s7, s7, s11
  s_mul_i32 s7, s7, 36864
  s_and_b32 s12, s4, 1
  s_mul_i32 s13, s12, 640
  s_lshl_b32 s12, s12, 6
  s_add_u32 s12, s12, 512
  v_lshrrev_b32 v3, 4, v1
  v_mul_u32_u24 v43, 9216, v3
  v_and_b32 v3, 15, v1
  v_lshl_add_u32 v2, v3, 4, v43
  v_add_u32 v2, s13, v2
  v_lshl_add_u32 v3, v3, 2, v43
  v_add_u32 v3, s12, v3
  buffer_load_dwordx4 v[192:195], v2, s[56:59], s7 offen offset:0 nt
  buffer_load_dwordx4 v[196:199], v2, s[56:59], s7 offen offset:256 nt
  buffer_load_dword v200, v3, s[56:59], s7 offen offset:0 nt
  buffer_load_dwordx4 v[204:207], v2, s[56:59], s7 offen offset:1152 nt
  buffer_load_dwordx4 v[208:211], v2, s[56:59], s7 offen offset:1408 nt
  buffer_load_dword v212, v3, s[56:59], s7 offen offset:1152 nt
  buffer_load_dwordx4 v[216:219], v2, s[56:59], s7 offen offset:2304 nt
  buffer_load_dwordx4 v[220:223], v2, s[56:59], s7 offen offset:2560 nt
  buffer_load_dword v224, v3, s[56:59], s7 offen offset:2304 nt
  s_add_u32 s7, s7, 3456
  buffer_load_dwordx4 v[228:231], v2, s[56:59], s7 offen offset:0 nt
  buffer_load_dwordx4 v[232:235], v2, s[56:59], s7 offen offset:256 nt
  buffer_load_dword v236, v3, s[56:59], s7 offen offset:0 nt
  buffer_load_dwordx4 v[240:243], v2, s[56:59], s7 offen offset:1152 nt
  buffer_load_dwordx4 v[244:247], v2, s[56:59], s7 offen offset:1408 nt
  buffer_load_dword v248, v3, s[56:59], s7 offen offset:1152 nt
  buffer_load_dwordx4 v[252:255], v2, s[56:59], s7 offen offset:2304 nt
  buffer_load_dwordx4 v[160:163], v2, s[56:59], s7 offen offset:2560 nt
  buffer_load_dword v164, v3, s[56:59], s7 offen offset:2304 nt
  s_add_u32 s7, s7, 3456
  buffer_load_dwordx4 v[168:171], v2, s[56:59], s7 offen offset:0 nt
  buffer_load_dwordx4 v[172:175], v2, s[56:59], s7 offen offset:256 nt
  buffer_load_dword v176, v3, s[56:59], s7 offen offset:0 nt
  buffer_load_dwordx4 v[180:183], v2, s[56:59], s7 offen offset:1152 nt
  buffer_load_dwordx4 v[184:187], v2, s[56:59], s7 offen offset:1408 nt
  buffer_load_dword v188, v3, s[56:59], s7 offen offset:1152 nt
  s_branch L_out
L_anf_18:
  s_cmp_lg_u32 s5, 1
  s_cbranch_scc1 L_endw
  s_cmp_lg_u32 s3, 0
  s_cbranch_scc1 L_endw
  s_branch L_fin
L_xwg:
  s_mov_b32 s96, 1
  s_and_b32 s97, s2, 7
  s_lshl_b32 s97, s97, 3
  s_lshr_b32 s7, s2, 5
  s_add_u32 s97, s97, s7
  s_waitcnt lgkmcnt(0)
  s_load_dword s6, s[42:43], 0
  s_mov_b32 s44, s42
  s_mov_b32 s45, s43
  s_mov_b32 s46, 0x10000000
  s_mov_b32 s47, 0x20000
  s_mov_b32 s48, s28
  s_mov_b32 s49, s29
  s_mov_b32 s50, 0x1000000
  s_mov_b32 s51, 0x20000
  s_and_b32 s7, s3, 1
  s_lshl_b32 s7, s7, 1
  v_xor_b32 v2, s7, v1
  v_xor_b32 v3, 0, v2
  v_lshlrev_b32 v40, 4, v3
  v_xor_b32 v3, 4, v2
  v_lshlrev_b32 v41, 4, v3
  v_xor_b32 v3, 8, v2
  v_lshlrev_b32 v42, 4, v3
  v_xor_b32 v3, 12, v2
  v_lshlrev_b32 v43, 4, v3
  v_xor_b32 v3, 3, v2
  v_lshlrev_b32 v44, 4, v3
  v_xor_b32 v3, 7, v2
  v_lshlrev_b32 v45, 4, v3
  v_xor_b32 v3, 11, v2
  v_lshlrev_b32 v46, 4, v3
  v_xor_b32 v3, 15, v2
  v_lshlrev_b32 v47, 4, v3
  s_lshl_b32 s66, s97, 18
  s_lshl_b32 s7, s3, 13
  s_add_u32 s66, s66, s7
  s_add_u32 m0, s7, 0
  s_nop 0
  buffer_load_dwordx4 v40, s[48:51], s66 offen nt lds
  s_add_u32 s66, s66, 1024
  s_add_u32 m0, s7, 1024
  s_nop 0
  buffer_load_dwordx4 v41, s[48:51], s66 offen nt lds
  s_add_u32 s66, s66, 1024
  s_add_u32 m0, s7, 2048
  s_nop 0
  buffer_load_dwordx4 v42, s[48:51], s66 offen nt lds
  s_add_u32 s66, s66, 1024
  s_add_u32 m0, s7, 3072
  s_nop 0
  buffer_load_dwordx4 v43, s[48:51], s66 offen nt lds
  s_add_u32 s66, s66, 1024
  s_add_u32 m0, s7, 4096
  s_nop 0
  buffer_load_dwordx4 v44, s[48:51], s66 offen nt lds
  s_add_u32 s66, s66, 1024
  s_add_u32 m0, s7, 5120
  s_nop 0
  buffer_load_dwordx4 v45, s[48:51], s66 offen nt lds
  s_add_u32 s66, s66, 1024
  s_add_u32 m0, s7, 6144
  s_nop 0
  buffer_load_dwordx4 v46, s[48:51], s66 offen nt lds
  s_add_u32 s66, s66, 1024
  s_add_u32 m0, s7, 7168
  s_nop 0
  buffer_load_dwordx4 v47, s[48:51], s66 offen nt lds
  s_add_u32 s66, s66, 58368
  s_add_u32 m0, s7, 65536
  s_nop 0
  buffer_load_dwordx4 v40, s[48:51], s66 offen nt lds
  s_add_u32 s66, s66, 1024
  s_add_u32 m0, s7, 66560
  s_nop 0
  buffer_load_dwordx4 v41, s[48:51], s66 offen nt lds
  s_add_u32 s66, s66, 1024
  s_add_u32 m0, s7, 67584
  s_nop 0
  buffer_load_dwordx4 v42, s[48:51], s66 offen nt lds
  s_add_u32 s66, s66, 1024
  s_add_u32 m0, s7, 68608
  s_nop 0
  buffer_load_dwordx4 v43, s[48:51], s66 offen nt lds
  s_add_u32 s66, s66, 1024
  s_add_u32 m0, s7, 69632
  s_nop 0
  buffer_load_dwordx4 v44, s[48:51], s66 offen nt lds
  s_add_u32 s66, s66, 1024
  s_add_u32 m0, s7, 70656
  s_nop 0
  buffer_load_dwordx4 v45, s[48:51], s66 offen nt lds
  s_add_u32 s66, s66, 1024
  s_add_u32 m0, s7, 71680
  s_nop 0
  buffer_load_dwordx4 v46, s[48:51], s66 offen nt lds
  s_add_u32 s66, s66, 1024
  s_add_u32 m0, s7, 72704
  s_nop 0
  buffer_load_dwordx4 v47, s[48:51], s66 offen nt lds
  s_add_u32 s66, s66, 58368
  buffer_load_dwordx4 v[192:195], v40, s[48:51], s66 offen nt
  s_add_u32 s66, s66, 1024
  buffer_load_dwordx4 v[196:199], v41, s[48:51], s66 offen nt
  s_add_u32 s66, s66, 1024
  buffer_load_dwordx4 v[200:203], v42, s[48:51], s66 offen nt
  s_add_u32 s66, s66, 1024
  buffer_load_dwordx4 v[204:207], v43, s[48:51], s66 offen nt
  s_add_u32 s66, s66, 1024
  buffer_load_dwordx4 v[208:211], v44, s[48:51], s66 offen nt
  s_add_u32 s66, s66, 1024
  buffer_load_dwordx4 v[212:215], v45, s[48:51], s66 offen nt
  s_add_u32 s66, s66, 1024
  buffer_load_dwordx4 v[216:219], v46, s[48:51], s66 offen nt
  s_add_u32 s66, s66, 1024
  buffer_load_dwordx4 v[220:223], v47, s[48:51], s66 offen nt
  s_add_u32 s66, s66, 58368
  buffer_load_dwordx4 v[224:227], v40, s[48:51], s66 offen nt
  s_add_u32 s66, s66, 1024
  buffer_load_dwordx4 v[228:231], v41, s[48:51], s66 offen nt
  s_add_u32 s66, s66, 1024
  buffer_load_dwordx4 v[232:235], v42, s[48:51], s66 offen nt
  s_add_u32 s66, s66, 1024
  buffer_load_dwordx4 v[236:239], v43, s[48:51], s66 offen nt
  s_add_u32 s66, s66, 1024
  buffer_load_dwordx4 v[240:243], v44, s[48:51], s66 offen nt
  s_add_u32 s66, s66, 1024
  buffer_load_dwordx4 v[244:247], v45, s[48:51], s66 offen nt
  s_add_u32 s66, s66, 1024
  buffer_load_dwordx4 v[248:251], v46, s[48:51], s66 offen nt
  s_add_u32 s66, s66, 1024
  buffer_load_dwordx4 v[252:255], v47, s[48:51], s66 offen nt
  s_add_u32 s66, s66, 58368
  s_waitcnt lgkmcnt(0)
  s_add_u32 s6, s6, 0x9e3779b9
  s_lshr_b32 s64, s3, 1
  s_and_b32 s65, s3, 1
  v_and_b32 v2, 3, v1
  v_lshlrev_b32 v2, 2, v2
  v_bfe_u32 v3, v1, 2, 1
  v_mul_u32_u24 v3, 3, v3
  v_bfe_u32 v8, v1, 3, 1
  v_lshlrev_b32 v8, 1, v8
  v_xor_b32 v3, v3, v8
  v_or_b32 v2, v2, v3
  v_lshrrev_b32 v3, 4, v1
  v_xor_b32 v2, v2, v3
  v_and_b32 v3, 15, v1
  v_lshlrev_b32 v3, 10, v3
  s_lshl_b32 s7, s64, 14
  v_add_u32 v3, s7, v3
  v_xor_b32 v8, 0, v2
  v_lshl_add_u32 v48, v8, 4, v3
  v_xor_b32 v8, 4, v2
  v_lshl_add_u32 v49, v8, 4, v3
  v_xor_b32 v8, 8, v2
  v_lshl_add_u32 v50, v8, 4, v3
  v_xor_b32 v8, 12, v2
  v_lshl_add_u32 v51, v8, 4, v3
  v_bfe_u32 v2, v1, 2, 2
  v_lshrrev_b32 v3, 5, v1
  v_lshl_add_u32 v8, v3, 3, v2
  v_lshlrev_b32 v8, 10, v8
  v_and_b32 v9, 1, v1
  v_lshl_add_u32 v8, v9, 3, v8
  s_lshl_b32 s7, s64, 8
  v_add_u32 v8, s7, v8
  v_bfe_u32 v9, v1, 4, 1
  v_xor_b32 v9, v9, v3
  v_lshlrev_b32 v9, 1, v9
  v_bfe_u32 v10, v1, 1, 1
  v_or_b32 v9, v9, v10
  v_lshl_or_b32 v9, v2, 2, v9
  s_lshl_b32 s7, s65, 3
  v_xor_b32 v9, s7, v9
  v_xor_b32 v10, 0, v9
  v_lshl_add_u32 v10, v10, 4, v8
  v_add_u32 v52, 0, v10
  v_xor_b32 v10, 3, v9
  v_lshl_add_u32 v10, v10, 4, v8
  v_add_u32 v53, 4096, v10
  v_xor_b32 v10, 4, v9
  v_lshl_add_u32 v10, v10, 4, v8
  v_add_u32 v54, 0, v10
  v_xor_b32 v10, 7, v9
  v_lshl_add_u32 v10, v10, 4, v8
  v_add_u32 v55, 4096, v10
  v_lshrrev_b32 v2, 5, v1
  v_lshlrev_b32 v2, 9, v2
  v_and_b32 v3, 15, v1
  v_lshl_add_u32 v2, v3, 4, v2
  v_bfe_u32 v8, v1, 4, 1
  v_lshl_add_u32 v2, v8, 3, v2
  s_lshl_b32 s7, s64, 10
  s_lshl_b32 s12, s65, 8
  s_add_u32 s7, s7, s12
  s_add_u32 s7, s7, 131072
  v_add_u32 v56, s7, v2
  v_lshlrev_b32 v57, 4, v1
  v_add_u32 v57, 0x20000, v57
  v_lshlrev_b32 v59, 4, v3
  s_add_u32 s12, s12, 135168
  v_add_u32 v59, s12, v59
  s_lshl_b32 s7, s64, 2
  v_add_u32 v58, s7, v59
  v_and_b32 v60, 31, v1
  v_lshlrev_b32 v60, 4, v60
  v_add_u32 v60, 0x21000, v60
  v_lshlrev_b32 v61, 4, v1
  s_lshl_b32 s7, s3, 13
  v_add_u32 v61, s7, v61
  v_mov_b32 v128, 0
  v_mov_b32 v129, 0
  v_mov_b32 v130, 0
  v_mov_b32 v131, 0
  v_mov_b32 v132, 0
  v_mov_b32 v133, 0
  v_mov_b32 v134, 0
  v_mov_b32 v135, 0
  v_mov_b32 v136, 0
  v_mov_b32 v137, 0
  v_mov_b32 v138, 0
  v_mov_b32 v139, 0
  v_mov_b32 v140, 0
  v_mov_b32 v141, 0
  v_mov_b32 v142, 0
  v_mov_b32 v143, 0
  v_mov_b32 v144, 0
  v_mov_b32 v145, 0
  v_mov_b32 v146, 0
  v_mov_b32 v147, 0
  v_mov_b32 v148, 0
  v_mov_b32 v149, 0
  v_mov_b32 v150, 0
  v_mov_b32 v151, 0
  v_mov_b32 v152, 0
  v_mov_b32 v153, 0
  v_mov_b32 v154, 0
  v_mov_b32 v155, 0
  v_mov_b32 v156, 0
  v_mov_b32 v157, 0
  v_mov_b32 v158, 0
  v_mov_b32 v159, 0
  v_mov_b32 v62, 0xff800000
  v_mov_b32 v23, 0xff800000
  v_mov_b32 v63, 0
  s_lshr_b32 s12, s97, 4
  s_lshl_b32 s12, s12, 16
  s_add_u32 s12, s12, s7
  s_add_u32 s60, s12, 0x280000
  s_add_u32 s61, s60, 4096
  v_lshlrev_b32 v2, 4, v1
  s_waitcnt vmcnt(0)
  s_barrier
  s_mov_b32 s15, 0x400000
  buffer_load_dwordx4 v[160:163], v2, s[44:47], s60 offen offset:0
  buffer_load_dwordx4 v[164:167], v2, s[44:47], s60 offen offset:1024
  buffer_load_dwordx4 v[168:171], v2, s[44:47], s60 offen offset:2048
  buffer_load_dwordx4 v[172:175], v2, s[44:47], s60 offen offset:3072
  buffer_load_dwordx4 v[176:179], v2, s[44:47], s61 offen offset:0
  buffer_load_dwordx4 v[180:183], v2, s[44:47], s61 offen offset:1024
  buffer_load_dwordx4 v[184:187], v2, s[44:47], s61 offen offset:2048
  buffer_load_dwordx4 v[188:191], v2, s[44:47], s61 offen offset:3072
  s_branch L_pgc_21
L_pg_19:
  buffer_load_dwordx4 v[160:163], v2, s[44:47], s60 offen offset:0 sc1
  buffer_load_dwordx4 v[164:167], v2, s[44:47], s60 offen offset:1024 sc1
  buffer_load_dwordx4 v[168:171], v2, s[44:47], s60 offen offset:2048 sc1
  buffer_load_dwordx4 v[172:175], v2, s[44:47], s60 offen offset:3072 sc1
  buffer_load_dwordx4 v[176:179], v2, s[44:47], s61 offen offset:0 sc1
  buffer_load_dwordx4 v[180:183], v2, s[44:47], s61 offen offset:1024 sc1
  buffer_load_dwordx4 v[184:187], v2, s[44:47], s61 offen offset:2048 sc1
  buffer_load_dwordx4 v[188:191], v2, s[44:47], s61 offen offset:3072 sc1
L_pgc_21:
  s_waitcnt vmcnt(0)
  v_and_b32 v8, v163, v167
  v_or_b32 v9, v163, v167
  v_and_b32 v8, v8, v171
  v_and_b32 v8, v8, v175
  v_and_b32 v8, v8, v179
  v_and_b32 v8, v8, v183
  v_and_b32 v8, v8, v187
  v_and_b32 v8, v8, v191
  v_or3_b32 v9, v9, v171, v175
  v_or3_b32 v9, v9, v179, v183
  v_or3_b32 v9, v9, v187, v191
  v_xor_b32 v8, s6, v8
  v_xor_b32 v9, s6, v9
  v_or_b32 v8, v8, v9
  v_cmp_ne_u32 vcc, 0, v8
  s_nop 4
  s_cbranch_vccz L_pgd_20
  s_mov_b64 exec, vcc
  s_sleep 4
  s_sub_u32 s15, s15, 1
  s_mov_b32 s14, 18
  s_cmp_eq_u32 s15, 0
  s_cbranch_scc1 L_fail
  s_bcnt1_i32_b64 s7, vcc
  s_cmp_le_u32 s7, 8
  s_cbranch_scc1 L_pg_19
  s_sleep 16
  s_branch L_pg_19
L_pgd_20:
  s_mov_b64 exec, -1
  v_lshlrev_b32 v2, 3, v1
  s_lshl_b32 s7, s3, 12
  s_add_u32 s7, s7, 131072
  v_add_u32 v2, s7, v2
  ds_write_b64 v2, v[160:161] offset:0
  ds_write_b64 v2, v[164:165] offset:512
  ds_write_b64 v2, v[168:169] offset:1024
  ds_write_b64 v2, v[172:173] offset:1536
  ds_write_b64 v2, v[176:177] offset:2048
  ds_write_b64 v2, v[180:181] offset:2560
  ds_write_b64 v2, v[184:185] offset:3072
  ds_write_b64 v2, v[188:189] offset:3584
  s_waitcnt lgkmcnt(0)
  s_barrier
  v_lshlrev_b32 v2, 4, v1
  s_lshl_b32 s7, s65, 14
  s_add_u32 s7, s7, 131072
  v_add_u32 v2, s7, v2
  ds_read_b128 v[64:67], v2 offset:0
  ds_read_b128 v[68:71], v2 offset:1024
  ds_read_b128 v[72:75], v2 offset:2048
  ds_read_b128 v[76:79], v2 offset:3072
  ds_read_b128 v[80:83], v2 offset:4096
  ds_read_b128 v[84:87], v2 offset:5120
  ds_read_b128 v[88:91], v2 offset:6144
  ds_read_b128 v[92:95], v2 offset:7168
  ds_read_b128 v[96:99], v2 offset:8192
  ds_read_b128 v[100:103], v2 offset:9216
  ds_read_b128 v[104:107], v2 offset:10240
  ds_read_b128 v[108:111], v2 offset:11264
  ds_read_b128 v[112:115], v2 offset:12288
  ds_read_b128 v[116:119], v2 offset:13312
  ds_read_b128 v[120:123], v2 offset:14336
  ds_read_b128 v[124:127], v2 offset:15360
  s_waitcnt lgkmcnt(0)
  s_barrier
  ds_read_b128 v[160:163], v48 offset:0
  ds_read_b128 v[164:167], v49 offset:0
  ds_read_b128 v[168:171], v50 offset:0
  ds_read_b128 v[172:175], v51 offset:0
  ds_read_b128 v[176:179], v48 offset:256
  ds_read_b128 v[180:183], v49 offset:256
  ds_read_b128 v[184:187], v50 offset:256
  ds_read_b128 v[188:191], v51 offset:256
  s_waitcnt lgkmcnt(7)
  v_mfma_f32_16x16x32_bf16 v[4:7], v[160:163], v[64:67], 0
  s_waitcnt lgkmcnt(6)
  v_mfma_f32_16x16x32_bf16 v[4:7], v[164:167], v[68:71], v[4:7]
  s_waitcnt lgkmcnt(5)
  v_mfma_f32_16x16x32_bf16 v[4:7], v[168:171], v[72:75], v[4:7]
  s_waitcnt lgkmcnt(4)
  v_mfma_f32_16x16x32_bf16 v[4:7], v[172:175], v[76:79], v[4:7]
  s_waitcnt lgkmcnt(3)
  v_mfma_f32_16x16x32_bf16 v[4:7], v[176:179], v[80:83], v[4:7]
  s_waitcnt lgkmcnt(2)
  v_mfma_f32_16x16x32_bf16 v[4:7], v[180:183], v[84:87], v[4:7]
  s_waitcnt lgkmcnt(1)
  v_mfma_f32_16x16x32_bf16 v[4:7], v[184:187], v[88:91], v[4:7]
  s_waitcnt lgkmcnt(0)
  v_mfma_f32_16x16x32_bf16 v[4:7], v[188:191], v[92:95], v[4:7]
  ds_read_b128 v[160:163], v48 offset:512
  ds_read_b128 v[164:167], v49 offset:512
  ds_read_b128 v[168:171], v50 offset:512
  ds_read_b128 v[172:175], v51 offset:512
  ds_read_b128 v[176:179], v48 offset:768
  ds_read_b128 v[180:183], v49 offset:768
  ds_read_b128 v[184:187], v50 offset:768
  ds_read_b128 v[188:191], v51 offset:768
  s_waitcnt lgkmcnt(7)
  v_mfma_f32_16x16x32_bf16 v[4:7], v[160:163], v[96:99], v[4:7]
  s_waitcnt lgkmcnt(6)
  v_mfma_f32_16x16x32_bf16 v[4:7], v[164:167], v[100:103], v[4:7]
  s_waitcnt lgkmcnt(5)
  v_mfma_f32_16x16x32_bf16 v[4:7], v[168:171], v[104:107], v[4:7]
  s_waitcnt lgkmcnt(4)
  v_mfma_f32_16x16x32_bf16 v[4:7], v[172:175], v[108:111], v[4:7]
  s_waitcnt lgkmcnt(3)
  v_mfma_f32_16x16x32_bf16 v[4:7], v[176:179], v[112:115], v[4:7]
  s_waitcnt lgkmcnt(2)
  v_mfma_f32_16x16x32_bf16 v[4:7], v[180:183], v[116:119], v[4:7]
  s_waitcnt lgkmcnt(1)
  v_mfma_f32_16x16x32_bf16 v[4:7], v[184:187], v[120:123], v[4:7]
  s_waitcnt lgkmcnt(0)
  v_mfma_f32_16x16x32_bf16 v[4:7], v[188:191], v[124:127], v[4:7]
  s_nop 7
  v_max3_f32 v2, v4, v5, v6
  v_max_f32 v2, v2, v7
  v_mov_b32 v3, v2
  s_nop 1
  v_permlane16_swap_b32 v2, v3
  v_max_f32 v2, v2, v3
  v_mov_b32 v3, v2
  s_nop 1
  v_permlane32_swap_b32 v2, v3
  v_max_f32 v2, v2, v3
  ds_write_b32 v58, v2
  s_waitcnt lgkmcnt(0)
  s_barrier
  ds_read_b128 v[12:15], v59
  ds_read_b128 v[16:19], v60
  ds_read_b64_tr_b16 v[160:161], v52 offset:0
  ds_read_b64_tr_b16 v[162:163], v53 offset:0
  ds_read_b64_tr_b16 v[164:165], v54 offset:0
  ds_read_b64_tr_b16 v[166:167], v55 offset:0
  ds_read_b64_tr_b16 v[168:169], v52 offset:16384
  ds_read_b64_tr_b16 v[170:171], v53 offset:16384
  ds_read_b64_tr_b16 v[172:173], v54 offset:16384
  ds_read_b64_tr_b16 v[174:175], v55 offset:16384
  ds_read_b64_tr_b16 v[176:177], v52 offset:32768
  ds_read_b64_tr_b16 v[178:179], v53 offset:32768
  ds_read_b64_tr_b16 v[180:181], v54 offset:32768
  ds_read_b64_tr_b16 v[182:183], v55 offset:32768
  ds_read_b64_tr_b16 v[184:185], v52 offset:49152
  ds_read_b64_tr_b16 v[186:187], v53 offset:49152
  ds_read_b64_tr_b16 v[188:189], v54 offset:49152
  ds_read_b64_tr_b16 v[190:191], v55 offset:49152
  s_waitcnt lgkmcnt(15)
  v_max3_f32 v12, v12, v13, v14
  v_max3_f32 v12, v12, v15, v62
  v_max3_f32 v16, v16, v17, v18
  v_max3_f32 v16, v16, v19, v23
  v_sub_f32 v13, v62, v12
  v_sub_f32 v17, v23, v16
  v_mul_f32 v13, s10, v13
  v_mul_f32 v17, s10, v17
  v_mov_b32 v62, v12
  v_mov_b32 v23, v16
  v_mul_f32 v12, s10, v12
  v_exp_f32 v13, v13
  v_exp_f32 v18, v17
  v_fma_f32 v4, v4, s10, -v12
  v_fma_f32 v5, v5, s10, -v12
  v_fma_f32 v6, v6, s10, -v12
  v_fma_f32 v7, v7, s10, -v12
  v_exp_f32 v4, v4
  v_exp_f32 v5, v5
  v_exp_f32 v6, v6
  v_exp_f32 v7, v7
  v_mov_b32 v19, v18
  v_cvt_pk_bf16_f32 v14, v4, v5
  v_cvt_pk_bf16_f32 v15, v6, v7
  ds_write_b64 v56, v[14:15]
  v_add_f32 v4, v4, v5
  v_add_f32 v6, v6, v7
  v_add_f32 v4, v4, v6
  v_fma_f32 v63, v63, v13, v4
  s_waitcnt lgkmcnt(0)
  s_barrier
  ds_read_b128 v[24:27], v57 offset:0
  ds_read_b128 v[28:31], v57 offset:1024
  ds_read_b128 v[32:35], v57 offset:2048
  ds_read_b128 v[36:39], v57 offset:3072
  s_waitcnt lgkmcnt(3)
  v_mfma_f32_32x32x16_bf16 v[128:143], v[160:163], v[24:27], v[128:143]
  v_mfma_f32_32x32x16_bf16 v[144:159], v[164:167], v[24:27], v[144:159]
  s_waitcnt lgkmcnt(2)
  v_mfma_f32_32x32x16_bf16 v[128:143], v[168:171], v[28:31], v[128:143]
  v_mfma_f32_32x32x16_bf16 v[144:159], v[172:175], v[28:31], v[144:159]
  s_waitcnt lgkmcnt(1)
  v_mfma_f32_32x32x16_bf16 v[128:143], v[176:179], v[32:35], v[128:143]
  v_mfma_f32_32x32x16_bf16 v[144:159], v[180:183], v[32:35], v[144:159]
  s_waitcnt lgkmcnt(0)
  v_mfma_f32_32x32x16_bf16 v[128:143], v[184:187], v[36:39], v[128:143]
  v_mfma_f32_32x32x16_bf16 v[144:159], v[188:191], v[36:39], v[144:159]
  v_xor_b32 v48, 0x10000, v48
  v_xor_b32 v49, 0x10000, v49
  v_xor_b32 v50, 0x10000, v50
  v_xor_b32 v51, 0x10000, v51
  v_xor_b32 v52, 0x10000, v52
  v_xor_b32 v53, 0x10000, v53
  v_xor_b32 v54, 0x10000, v54
  v_xor_b32 v55, 0x10000, v55
  ds_read_b128 v[160:163], v48 offset:0
  ds_read_b128 v[164:167], v49 offset:0
  ds_read_b128 v[168:171], v50 offset:0
  ds_read_b128 v[172:175], v51 offset:0
  ds_read_b128 v[176:179], v48 offset:256
  ds_read_b128 v[180:183], v49 offset:256
  ds_read_b128 v[184:187], v50 offset:256
  ds_read_b128 v[188:191], v51 offset:256
  s_waitcnt lgkmcnt(7)
  v_mfma_f32_16x16x32_bf16 v[4:7], v[160:163], v[64:67], 0
  s_waitcnt lgkmcnt(6)
  v_mfma_f32_16x16x32_bf16 v[4:7], v[164:167], v[68:71], v[4:7]
  s_waitcnt lgkmcnt(5)
  v_mfma_f32_16x16x32_bf16 v[4:7], v[168:171], v[72:75], v[4:7]
  s_waitcnt lgkmcnt(4)
  v_mfma_f32_16x16x32_bf16 v[4:7], v[172:175], v[76:79], v[4:7]
  s_waitcnt lgkmcnt(3)
  v_mfma_f32_16x16x32_bf16 v[4:7], v[176:179], v[80:83], v[4:7]
  s_waitcnt lgkmcnt(2)
  v_mfma_f32_16x16x32_bf16 v[4:7], v[180:183], v[84:87], v[4:7]
  s_waitcnt lgkmcnt(1)
  v_mfma_f32_16x16x32_bf16 v[4:7], v[184:187], v[88:91], v[4:7]
  s_waitcnt lgkmcnt(0)
  v_mfma_f32_16x16x32_bf16 v[4:7], v[188:191], v[92:95], v[4:7]
  ds_read_b128 v[160:163], v48 offset:512
  ds_read_b128 v[164:167], v49 offset:512
  ds_read_b128 v[168:171], v50 offset:512
  ds_read_b128 v[172:175], v51 offset:512
  ds_read_b128 v[176:179], v48 offset:768
  ds_read_b128 v[180:183], v49 offset:768
  ds_read_b128 v[184:187], v50 offset:768
  ds_read_b128 v[188:191], v51 offset:768
  s_waitcnt lgkmcnt(7)
  v_mfma_f32_16x16x32_bf16 v[4:7], v[160:163], v[96:99], v[4:7]
  s_waitcnt lgkmcnt(6)
  v_mfma_f32_16x16x32_bf16 v[4:7], v[164:167], v[100:103], v[4:7]
  s_waitcnt lgkmcnt(5)
  v_mfma_f32_16x16x32_bf16 v[4:7], v[168:171], v[104:107], v[4:7]
  s_waitcnt lgkmcnt(4)
  v_mfma_f32_16x16x32_bf16 v[4:7], v[172:175], v[108:111], v[4:7]
  s_waitcnt lgkmcnt(3)
  v_mfma_f32_16x16x32_bf16 v[4:7], v[176:179], v[112:115], v[4:7]
  s_waitcnt lgkmcnt(2)
  v_mfma_f32_16x16x32_bf16 v[4:7], v[180:183], v[116:119], v[4:7]
  s_waitcnt lgkmcnt(1)
  v_mfma_f32_16x16x32_bf16 v[4:7], v[184:187], v[120:123], v[4:7]
  s_waitcnt lgkmcnt(0)
  v_mfma_f32_16x16x32_bf16 v[4:7], v[188:191], v[124:127], v[4:7]
  s_nop 7
  v_max3_f32 v2, v4, v5, v6
  v_max_f32 v2, v2, v7
  v_mov_b32 v3, v2
  s_nop 1
  v_permlane16_swap_b32 v2, v3
  v_max_f32 v2, v2, v3
  v_mov_b32 v3, v2
  s_nop 1
  v_permlane32_swap_b32 v2, v3
  v_max_f32 v2, v2, v3
  ds_write_b32 v58, v2
  s_waitcnt lgkmcnt(0)
  s_barrier
  ds_read_b128 v[12:15], v59
  ds_read_b128 v[16:19], v60
  ds_read_b64_tr_b16 v[160:161], v52 offset:0
  ds_read_b64_tr_b16 v[162:163], v53 offset:0
  ds_read_b64_tr_b16 v[164:165], v54 offset:0
  ds_read_b64_tr_b16 v[166:167], v55 offset:0
  ds_read_b64_tr_b16 v[168:169], v52 offset:16384
  ds_read_b64_tr_b16 v[170:171], v53 offset:16384
  ds_read_b64_tr_b16 v[172:173], v54 offset:16384
  ds_read_b64_tr_b16 v[174:175], v55 offset:16384
  ds_read_b64_tr_b16 v[176:177], v52 offset:32768
  ds_read_b64_tr_b16 v[178:179], v53 offset:32768
  ds_read_b64_tr_b16 v[180:181], v54 offset:32768
  ds_read_b64_tr_b16 v[182:183], v55 offset:32768
  ds_read_b64_tr_b16 v[184:185], v52 offset:49152
  ds_read_b64_tr_b16 v[186:187], v53 offset:49152
  ds_read_b64_tr_b16 v[188:189], v54 offset:49152
  ds_read_b64_tr_b16 v[190:191], v55 offset:49152
  s_waitcnt vmcnt(0)
  ds_write_b128 v61, v[192:195] offset:0
  ds_write_b128 v61, v[196:199] offset:1024
  ds_write_b128 v61, v[200:203] offset:2048
  ds_write_b128 v61, v[204:207] offset:3072
  ds_write_b128 v61, v[208:211] offset:4096
  ds_write_b128 v61, v[212:215] offset:5120
  ds_write_b128 v61, v[216:219] offset:6144
  ds_write_b128 v61, v[220:223] offset:7168
  v_xor_b32 v61, 0x10000, v61
  s_waitcnt lgkmcnt(15)
  v_max3_f32 v12, v12, v13, v14
  v_max3_f32 v12, v12, v15, v62
  v_max3_f32 v16, v16, v17, v18
  v_max3_f32 v16, v16, v19, v23
  v_sub_f32 v13, v62, v12
  v_sub_f32 v17, v23, v16
  v_mul_f32 v13, s10, v13
  v_mul_f32 v17, s10, v17
  v_mov_b32 v62, v12
  v_mov_b32 v23, v16
  v_mul_f32 v12, s10, v12
  v_exp_f32 v13, v13
  v_exp_f32 v18, v17
  v_fma_f32 v4, v4, s10, -v12
  v_fma_f32 v5, v5, s10, -v12
  v_fma_f32 v6, v6, s10, -v12
  v_fma_f32 v7, v7, s10, -v12
  v_exp_f32 v4, v4
  v_exp_f32 v5, v5
  v_exp_f32 v6, v6
  v_exp_f32 v7, v7
  v_mov_b32 v19, v18
  v_cvt_pk_bf16_f32 v14, v4, v5
  v_cvt_pk_bf16_f32 v15, v6, v7
  ds_write_b64 v56, v[14:15]
  v_add_f32 v4, v4, v5
  v_add_f32 v6, v6, v7
  v_add_f32 v4, v4, v6
  v_fma_f32 v63, v63, v13, v4
  v_pk_mul_f32 v[128:129], v[128:129], v[18:19]
  v_pk_mul_f32 v[130:131], v[130:131], v[18:19]
  v_pk_mul_f32 v[132:133], v[132:133], v[18:19]
  v_pk_mul_f32 v[134:135], v[134:135], v[18:19]
  v_pk_mul_f32 v[136:137], v[136:137], v[18:19]
  v_pk_mul_f32 v[138:139], v[138:139], v[18:19]
  v_pk_mul_f32 v[140:141], v[140:141], v[18:19]
  v_pk_mul_f32 v[142:143], v[142:143], v[18:19]
  v_pk_mul_f32 v[144:145], v[144:145], v[18:19]
  v_pk_mul_f32 v[146:147], v[146:147], v[18:19]
  v_pk_mul_f32 v[148:149], v[148:149], v[18:19]
  v_pk_mul_f32 v[150:151], v[150:151], v[18:19]
  v_pk_mul_f32 v[152:153], v[152:153], v[18:19]
  v_pk_mul_f32 v[154:155], v[154:155], v[18:19]
  v_pk_mul_f32 v[156:157], v[156:157], v[18:19]
  v_pk_mul_f32 v[158:159], v[158:159], v[18:19]
  s_waitcnt lgkmcnt(0)
  s_barrier
  ds_read_b128 v[24:27], v57 offset:0
  ds_read_b128 v[28:31], v57 offset:1024
  ds_read_b128 v[32:35], v57 offset:2048
  ds_read_b128 v[36:39], v57 offset:3072
  s_cmp_lt_u32 s3, 4
  s_cbranch_scc1 L_bti_22
  s_mov_b32 s52, s34
  s_mov_b32 s53, s35
  s_mov_b32 s54, 0x400000
  s_mov_b32 s55, 0x20000
  s_and_b32 s7, s4, 1
  s_lshl_b32 s7, s7, 2
  s_add_u32 s7, s7, s11
  s_lshl_b32 s7, s7, 19
  s_lshr_b32 s12, s4, 1
  s_lshl_b32 s12, s12, 8
  s_add_u32 s7, s7, s12
  v_lshrrev_b32 v3, 4, v1
  v_lshlrev_b32 v2, 16, v3
  v_and_b32 v3, 15, v1
  v_lshl_add_u32 v2, v3, 4, v2
  buffer_load_dwordx4 v[192:195], v2, s[52:55], s7 offen nt
  s_add_u32 s7, s7, 8192
  buffer_load_dwordx4 v[196:199], v2, s[52:55], s7 offen nt
  s_add_u32 s7, s7, 8192
  buffer_load_dwordx4 v[200:203], v2, s[52:55], s7 offen nt
  s_add_u32 s7, s7, 8192
  buffer_load_dwordx4 v[204:207], v2, s[52:55], s7 offen nt
  s_add_u32 s7, s7, 8192
  buffer_load_dwordx4 v[208:211], v2, s[52:55], s7 offen nt
  s_add_u32 s7, s7, 8192
  buffer_load_dwordx4 v[212:215], v2, s[52:55], s7 offen nt
  s_add_u32 s7, s7, 8192
  buffer_load_dwordx4 v[216:219], v2, s[52:55], s7 offen nt
  s_add_u32 s7, s7, 8192
  buffer_load_dwordx4 v[220:223], v2, s[52:55], s7 offen nt
  s_branch L_bte_23
L_bti_22:
L_bte_23:
  s_waitcnt lgkmcnt(3)
  v_mfma_f32_32x32x16_bf16 v[128:143], v[160:163], v[24:27], v[128:143]
  v_mfma_f32_32x32x16_bf16 v[144:159], v[164:167], v[24:27], v[144:159]
  s_waitcnt lgkmcnt(2)
  v_mfma_f32_32x32x16_bf16 v[128:143], v[168:171], v[28:31], v[128:143]
  v_mfma_f32_32x32x16_bf16 v[144:159], v[172:175], v[28:31], v[144:159]
  s_waitcnt lgkmcnt(1)
  v_mfma_f32_32x32x16_bf16 v[128:143], v[176:179], v[32:35], v[128:143]
  v_mfma_f32_32x32x16_bf16 v[144:159], v[180:183], v[32:35], v[144:159]
  s_waitcnt lgkmcnt(0)
  v_mfma_f32_32x32x16_bf16 v[128:143], v[184:187], v[36:39], v[128:143]
  v_mfma_f32_32x32x16_bf16 v[144:159], v[188:191], v[36:39], v[144:159]
  v_xor_b32 v48, 0x10000, v48
  v_xor_b32 v49, 0x10000, v49
  v_xor_b32 v50, 0x10000, v50
  v_xor_b32 v51, 0x10000, v51
  v_xor_b32 v52, 0x10000, v52
  v_xor_b32 v53, 0x10000, v53
  v_xor_b32 v54, 0x10000, v54
  v_xor_b32 v55, 0x10000, v55
  ds_read_b128 v[160:163], v48 offset:0
  ds_read_b128 v[164:167], v49 offset:0
  ds_read_b128 v[168:171], v50 offset:0
  ds_read_b128 v[172:175], v51 offset:0
  ds_read_b128 v[176:179], v48 offset:256
  ds_read_b128 v[180:183], v49 offset:256
  ds_read_b128 v[184:187], v50 offset:256
  ds_read_b128 v[188:191], v51 offset:256
  s_waitcnt lgkmcnt(7)
  v_mfma_f32_16x16x32_bf16 v[4:7], v[160:163], v[64:67], 0
  s_waitcnt lgkmcnt(6)
  v_mfma_f32_16x16x32_bf16 v[4:7], v[164:167], v[68:71], v[4:7]
  s_waitcnt lgkmcnt(5)
  v_mfma_f32_16x16x32_bf16 v[4:7], v[168:171], v[72:75], v[4:7]
  s_waitcnt lgkmcnt(4)
  v_mfma_f32_16x16x32_bf16 v[4:7], v[172:175], v[76:79], v[4:7]
  s_waitcnt lgkmcnt(3)
  v_mfma_f32_16x16x32_bf16 v[4:7], v[176:179], v[80:83], v[4:7]
  s_waitcnt lgkmcnt(2)
  v_mfma_f32_16x16x32_bf16 v[4:7], v[180:183], v[84:87], v[4:7]
  s_waitcnt lgkmcnt(1)
  v_mfma_f32_16x16x32_bf16 v[4:7], v[184:187], v[88:91], v[4:7]
  s_waitcnt lgkmcnt(0)
  v_mfma_f32_16x16x32_bf16 v[4:7], v[188:191], v[92:95], v[4:7]
  ds_read_b128 v[160:163], v48 offset:512
  ds_read_b128 v[164:167], v49 offset:512
  ds_read_b128 v[168:171], v50 offset:512
  ds_read_b128 v[172:175], v51 offset:512
  ds_read_b128 v[176:179], v48 offset:768
  ds_read_b128 v[180:183], v49 offset:768
  ds_read_b128 v[184:187], v50 offset:768
  ds_read_b128 v[188:191], v51 offset:768
  s_waitcnt lgkmcnt(7)
  v_mfma_f32_16x16x32_bf16 v[4:7], v[160:163], v[96:99], v[4:7]
  s_waitcnt lgkmcnt(6)
  v_mfma_f32_16x16x32_bf16 v[4:7], v[164:167], v[100:103], v[4:7]
  s_waitcnt lgkmcnt(5)
  v_mfma_f32_16x16x32_bf16 v[4:7], v[168:171], v[104:107], v[4:7]
  s_waitcnt lgkmcnt(4)
  v_mfma_f32_16x16x32_bf16 v[4:7], v[172:175], v[108:111], v[4:7]
  s_waitcnt lgkmcnt(3)
  v_mfma_f32_16x16x32_bf16 v[4:7], v[176:179], v[112:115], v[4:7]
  s_waitcnt lgkmcnt(2)
  v_mfma_f32_16x16x32_bf16 v[4:7], v[180:183], v[116:119], v[4:7]
  s_waitcnt lgkmcnt(1)
  v_mfma_f32_16x16x32_bf16 v[4:7], v[184:187], v[120:123], v[4:7]
  s_waitcnt lgkmcnt(0)
  v_mfma_f32_16x16x32_bf16 v[4:7], v[188:191], v[124:127], v[4:7]
  s_nop 7
  v_max3_f32 v2, v4, v5, v6
  v_max_f32 v2, v2, v7
  v_mov_b32 v3, v2
  s_nop 1
  v_permlane16_swap_b32 v2, v3
  v_max_f32 v2, v2, v3
  v_mov_b32 v3, v2
  s_nop 1
  v_permlane32_swap_b32 v2, v3
  v_max_f32 v2, v2, v3
  ds_write_b32 v58, v2
  s_waitcnt lgkmcnt(0)
  s_barrier
  ds_read_b128 v[12:15], v59
  ds_read_b128 v[16:19], v60
  ds_read_b64_tr_b16 v[160:161], v52 offset:0
  ds_read_b64_tr_b16 v[162:163], v53 offset:0
  ds_read_b64_tr_b16 v[164:165], v54 offset:0
  ds_read_b64_tr_b16 v[166:167], v55 offset:0
  ds_read_b64_tr_b16 v[168:169], v52 offset:16384
  ds_read_b64_tr_b16 v[170:171], v53 offset:16384
  ds_read_b64_tr_b16 v[172:173], v54 offset:16384
  ds_read_b64_tr_b16 v[174:175], v55 offset:16384
  ds_read_b64_tr_b16 v[176:177], v52 offset:32768
  ds_read_b64_tr_b16 v[178:179], v53 offset:32768
  ds_read_b64_tr_b16 v[180:181], v54 offset:32768
  ds_read_b64_tr_b16 v[182:183], v55 offset:32768
  ds_read_b64_tr_b16 v[184:185], v52 offset:49152
  ds_read_b64_tr_b16 v[186:187], v53 offset:49152
  ds_read_b64_tr_b16 v[188:189], v54 offset:49152
  ds_read_b64_tr_b16 v[190:191], v55 offset:49152
  ds_write_b128 v61, v[224:227] offset:0
  ds_write_b128 v61, v[228:231] offset:1024
  ds_write_b128 v61, v[232:235] offset:2048
  ds_write_b128 v61, v[236:239] offset:3072
  ds_write_b128 v61, v[240:243] offset:4096
  ds_write_b128 v61, v[244:247] offset:5120
  ds_write_b128 v61, v[248:251] offset:6144
  ds_write_b128 v61, v[252:255] offset:7168
  v_xor_b32 v61, 0x10000, v61
  s_waitcnt lgkmcnt(15)
  v_max3_f32 v12, v12, v13, v14
  v_max3_f32 v12, v12, v15, v62
  v_max3_f32 v16, v16, v17, v18
  v_max3_f32 v16, v16, v19, v23
  v_sub_f32 v13, v62, v12
  v_sub_f32 v17, v23, v16
  v_mul_f32 v13, s10, v13
  v_mul_f32 v17, s10, v17
  v_mov_b32 v62, v12
  v_mov_b32 v23, v16
  v_mul_f32 v12, s10, v12
  v_exp_f32 v13, v13
  v_exp_f32 v18, v17
  v_fma_f32 v4, v4, s10, -v12
  v_fma_f32 v5, v5, s10, -v12
  v_fma_f32 v6, v6, s10, -v12
  v_fma_f32 v7, v7, s10, -v12
  v_exp_f32 v4, v4
  v_exp_f32 v5, v5
  v_exp_f32 v6, v6
  v_exp_f32 v7, v7
  v_mov_b32 v19, v18
  v_cvt_pk_bf16_f32 v14, v4, v5
  v_cvt_pk_bf16_f32 v15, v6, v7
  ds_write_b64 v56, v[14:15]
  v_add_f32 v4, v4, v5
  v_add_f32 v6, v6, v7
  v_add_f32 v4, v4, v6
  v_fma_f32 v63, v63, v13, v4
  v_pk_mul_f32 v[128:129], v[128:129], v[18:19]
  v_pk_mul_f32 v[130:131], v[130:131], v[18:19]
  v_pk_mul_f32 v[132:133], v[132:133], v[18:19]
  v_pk_mul_f32 v[134:135], v[134:135], v[18:19]
  v_pk_mul_f32 v[136:137], v[136:137], v[18:19]
  v_pk_mul_f32 v[138:139], v[138:139], v[18:19]
  v_pk_mul_f32 v[140:141], v[140:141], v[18:19]
  v_pk_mul_f32 v[142:143], v[142:143], v[18:19]
  v_pk_mul_f32 v[144:145], v[144:145], v[18:19]
  v_pk_mul_f32 v[146:147], v[146:147], v[18:19]
  v_pk_mul_f32 v[148:149], v[148:149], v[18:19]
  v_pk_mul_f32 v[150:151], v[150:151], v[18:19]
  v_pk_mul_f32 v[152:153], v[152:153], v[18:19]
  v_pk_mul_f32 v[154:155], v[154:155], v[18:19]
  v_pk_mul_f32 v[156:157], v[156:157], v[18:19]
  v_pk_mul_f32 v[158:159], v[158:159], v[18:19]
  s_waitcnt lgkmcnt(0)
  s_barrier
  ds_read_b128 v[24:27], v57 offset:0
  ds_read_b128 v[28:31], v57 offset:1024
  ds_read_b128 v[32:35], v57 offset:2048
  ds_read_b128 v[36:39], v57 offset:3072
  s_cmp_lt_u32 s3, 4
  s_cbranch_scc1 L_bti_24
  s_mov_b32 s52, s34
  s_mov_b32 s53, s35
  s_mov_b32 s54, 0x400000
  s_mov_b32 s55, 0x20000
  s_and_b32 s7, s4, 1
  s_lshl_b32 s7, s7, 2
  s_add_u32 s7, s7, s11
  s_lshl_b32 s7, s7, 19
  s_lshr_b32 s12, s4, 1
  s_lshl_b32 s12, s12, 8
  s_add_u32 s7, s7, s12
  v_lshrrev_b32 v3, 4, v1
  v_lshlrev_b32 v2, 16, v3
  v_and_b32 v3, 15, v1
  v_lshl_add_u32 v2, v3, 4, v2
  s_add_u32 s7, s7, 262144
  buffer_load_dwordx4 v[224:227], v2, s[52:55], s7 offen nt
  s_add_u32 s7, s7, 8192
  buffer_load_dwordx4 v[228:231], v2, s[52:55], s7 offen nt
  s_add_u32 s7, s7, 8192
  buffer_load_dwordx4 v[232:235], v2, s[52:55], s7 offen nt
  s_add_u32 s7, s7, 8192
  buffer_load_dwordx4 v[236:239], v2, s[52:55], s7 offen nt
  s_add_u32 s7, s7, 8192
  buffer_load_dwordx4 v[240:243], v2, s[52:55], s7 offen nt
  s_add_u32 s7, s7, 8192
  buffer_load_dwordx4 v[244:247], v2, s[52:55], s7 offen nt
  s_add_u32 s7, s7, 8192
  buffer_load_dwordx4 v[248:251], v2, s[52:55], s7 offen nt
  s_add_u32 s7, s7, 8192
  buffer_load_dwordx4 v[252:255], v2, s[52:55], s7 offen nt
  s_branch L_bte_25
L_bti_24:
L_bte_25:
  s_waitcnt lgkmcnt(3)
  v_mfma_f32_32x32x16_bf16 v[128:143], v[160:163], v[24:27], v[128:143]
  v_mfma_f32_32x32x16_bf16 v[144:159], v[164:167], v[24:27], v[144:159]
  s_waitcnt lgkmcnt(2)
  v_mfma_f32_32x32x16_bf16 v[128:143], v[168:171], v[28:31], v[128:143]
  v_mfma_f32_32x32x16_bf16 v[144:159], v[172:175], v[28:31], v[144:159]
  s_waitcnt lgkmcnt(1)
  v_mfma_f32_32x32x16_bf16 v[128:143], v[176:179], v[32:35], v[128:143]
  v_mfma_f32_32x32x16_bf16 v[144:159], v[180:183], v[32:35], v[144:159]
  s_waitcnt lgkmcnt(0)
  v_mfma_f32_32x32x16_bf16 v[128:143], v[184:187], v[36:39], v[128:143]
  v_mfma_f32_32x32x16_bf16 v[144:159], v[188:191], v[36:39], v[144:159]
  v_xor_b32 v48, 0x10000, v48
  v_xor_b32 v49, 0x10000, v49
  v_xor_b32 v50, 0x10000, v50
  v_xor_b32 v51, 0x10000, v51
  v_xor_b32 v52, 0x10000, v52
  v_xor_b32 v53, 0x10000, v53
  v_xor_b32 v54, 0x10000, v54
  v_xor_b32 v55, 0x10000, v55
  ds_read_b128 v[160:163], v48 offset:0
  ds_read_b128 v[164:167], v49 offset:0
  ds_read_b128 v[168:171], v50 offset:0
  ds_read_b128 v[172:175], v51 offset:0
  ds_read_b128 v[176:179], v48 offset:256
  ds_read_b128 v[180:183], v49 offset:256
  ds_read_b128 v[184:187], v50 offset:256
  ds_read_b128 v[188:191], v51 offset:256
  s_waitcnt lgkmcnt(7)
  v_mfma_f32_16x16x32_bf16 v[4:7], v[160:163], v[64:67], 0
  s_waitcnt lgkmcnt(6)
  v_mfma_f32_16x16x32_bf16 v[4:7], v[164:167], v[68:71], v[4:7]
  s_waitcnt lgkmcnt(5)
  v_mfma_f32_16x16x32_bf16 v[4:7], v[168:171], v[72:75], v[4:7]
  s_waitcnt lgkmcnt(4)
  v_mfma_f32_16x16x32_bf16 v[4:7], v[172:175], v[76:79], v[4:7]
  s_waitcnt lgkmcnt(3)
  v_mfma_f32_16x16x32_bf16 v[4:7], v[176:179], v[80:83], v[4:7]
  s_waitcnt lgkmcnt(2)
  v_mfma_f32_16x16x32_bf16 v[4:7], v[180:183], v[84:87], v[4:7]
  s_waitcnt lgkmcnt(1)
  v_mfma_f32_16x16x32_bf16 v[4:7], v[184:187], v[88:91], v[4:7]
  s_waitcnt lgkmcnt(0)
  v_mfma_f32_16x16x32_bf16 v[4:7], v[188:191], v[92:95], v[4:7]
  ds_read_b128 v[160:163], v48 offset:512
  ds_read_b128 v[164:167], v49 offset:512
  ds_read_b128 v[168:171], v50 offset:512
  ds_read_b128 v[172:175], v51 offset:512
  ds_read_b128 v[176:179], v48 offset:768
  ds_read_b128 v[180:183], v49 offset:768
  ds_read_b128 v[184:187], v50 offset:768
  ds_read_b128 v[188:191], v51 offset:768
  s_waitcnt lgkmcnt(7)
  v_mfma_f32_16x16x32_bf16 v[4:7], v[160:163], v[96:99], v[4:7]
  s_waitcnt lgkmcnt(6)
  v_mfma_f32_16x16x32_bf16 v[4:7], v[164:167], v[100:103], v[4:7]
  s_waitcnt lgkmcnt(5)
  v_mfma_f32_16x16x32_bf16 v[4:7], v[168:171], v[104:107], v[4:7]
  s_waitcnt lgkmcnt(4)
  v_mfma_f32_16x16x32_bf16 v[4:7], v[172:175], v[108:111], v[4:7]
  s_waitcnt lgkmcnt(3)
  v_mfma_f32_16x16x32_bf16 v[4:7], v[176:179], v[112:115], v[4:7]
  s_waitcnt lgkmcnt(2)
  v_mfma_f32_16x16x32_bf16 v[4:7], v[180:183], v[116:119], v[4:7]
  s_waitcnt lgkmcnt(1)
  v_mfma_f32_16x16x32_bf16 v[4:7], v[184:187], v[120:123], v[4:7]
  s_waitcnt lgkmcnt(0)
  v_mfma_f32_16x16x32_bf16 v[4:7], v[188:191], v[124:127], v[4:7]
  s_nop 7
  v_max3_f32 v2, v4, v5, v6
  v_max_f32 v2, v2, v7
  v_mov_b32 v3, v2
  s_nop 1
  v_permlane16_swap_b32 v2, v3
  v_max_f32 v2, v2, v3
  v_mov_b32 v3, v2
  s_nop 1
  v_permlane32_swap_b32 v2, v3
  v_max_f32 v2, v2, v3
  ds_write_b32 v58, v2
  s_waitcnt lgkmcnt(0)
  s_barrier
  ds_read_b128 v[12:15], v59
  ds_read_b128 v[16:19], v60
  ds_read_b64_tr_b16 v[160:161], v52 offset:0
  ds_read_b64_tr_b16 v[162:163], v53 offset:0
  ds_read_b64_tr_b16 v[164:165], v54 offset:0
  ds_read_b64_tr_b16 v[166:167], v55 offset:0
  ds_read_b64_tr_b16 v[168:169], v52 offset:16384
  ds_read_b64_tr_b16 v[170:171], v53 offset:16384
  ds_read_b64_tr_b16 v[172:173], v54 offset:16384
  ds_read_b64_tr_b16 v[174:175], v55 offset:16384
  ds_read_b64_tr_b16 v[176:177], v52 offset:32768
  ds_read_b64_tr_b16 v[178:179], v53 offset:32768
  ds_read_b64_tr_b16 v[180:181], v54 offset:32768
  ds_read_b64_tr_b16 v[182:183], v55 offset:32768
  ds_read_b64_tr_b16 v[184:185], v52 offset:49152
  ds_read_b64_tr_b16 v[186:187], v53 offset:49152
  ds_read_b64_tr_b16 v[188:189], v54 offset:49152
  ds_read_b64_tr_b16 v[190:191], v55 offset:49152
  s_waitcnt lgkmcnt(15)
  v_max3_f32 v12, v12, v13, v14
  v_max3_f32 v12, v12, v15, v62
  v_max3_f32 v16, v16, v17, v18
  v_max3_f32 v16, v16, v19, v23
  v_sub_f32 v13, v62, v12
  v_sub_f32 v17, v23, v16
  v_mul_f32 v13, s10, v13
  v_mul_f32 v17, s10, v17
  v_mov_b32 v62, v12
  v_mov_b32 v23, v16
  v_mul_f32 v12, s10, v12
  v_exp_f32 v13, v13
  v_exp_f32 v18, v17
  v_fma_f32 v4, v4, s10, -v12
  v_fma_f32 v5, v5, s10, -v12
  v_fma_f32 v6, v6, s10, -v12
  v_fma_f32 v7, v7, s10, -v12
  v_exp_f32 v4, v4
  v_exp_f32 v5, v5
  v_exp_f32 v6, v6
  v_exp_f32 v7, v7
  v_mov_b32 v19, v18
  v_cvt_pk_bf16_f32 v14, v4, v5
  v_cvt_pk_bf16_f32 v15, v6, v7
  ds_write_b64 v56, v[14:15]
  v_add_f32 v4, v4, v5
  v_add_f32 v6, v6, v7
  v_add_f32 v4, v4, v6
  v_fma_f32 v63, v63, v13, v4
  v_pk_mul_f32 v[128:129], v[128:129], v[18:19]
  v_pk_mul_f32 v[130:131], v[130:131], v[18:19]
  v_pk_mul_f32 v[132:133], v[132:133], v[18:19]
  v_pk_mul_f32 v[134:135], v[134:135], v[18:19]
  v_pk_mul_f32 v[136:137], v[136:137], v[18:19]
  v_pk_mul_f32 v[138:139], v[138:139], v[18:19]
  v_pk_mul_f32 v[140:141], v[140:141], v[18:19]
  v_pk_mul_f32 v[142:143], v[142:143], v[18:19]
  v_pk_mul_f32 v[144:145], v[144:145], v[18:19]
  v_pk_mul_f32 v[146:147], v[146:147], v[18:19]
  v_pk_mul_f32 v[148:149], v[148:149], v[18:19]
  v_pk_mul_f32 v[150:151], v[150:151], v[18:19]
  v_pk_mul_f32 v[152:153], v[152:153], v[18:19]
  v_pk_mul_f32 v[154:155], v[154:155], v[18:19]
  v_pk_mul_f32 v[156:157], v[156:157], v[18:19]
  v_pk_mul_f32 v[158:159], v[158:159], v[18:19]
  s_waitcnt lgkmcnt(0)
  s_barrier
  ds_read_b128 v[24:27], v57 offset:0
  ds_read_b128 v[28:31], v57 offset:1024
  ds_read_b128 v[32:35], v57 offset:2048
  ds_read_b128 v[36:39], v57 offset:3072
  s_waitcnt lgkmcnt(3)
  v_mfma_f32_32x32x16_bf16 v[128:143], v[160:163], v[24:27], v[128:143]
  v_mfma_f32_32x32x16_bf16 v[144:159], v[164:167], v[24:27], v[144:159]
  s_waitcnt lgkmcnt(2)
  v_mfma_f32_32x32x16_bf16 v[128:143], v[168:171], v[28:31], v[128:143]
  v_mfma_f32_32x32x16_bf16 v[144:159], v[172:175], v[28:31], v[144:159]
  s_waitcnt lgkmcnt(1)
  v_mfma_f32_32x32x16_bf16 v[128:143], v[176:179], v[32:35], v[128:143]
  v_mfma_f32_32x32x16_bf16 v[144:159], v[180:183], v[32:35], v[144:159]
  s_waitcnt lgkmcnt(0)
  v_mfma_f32_32x32x16_bf16 v[128:143], v[184:187], v[36:39], v[128:143]
  v_mfma_f32_32x32x16_bf16 v[144:159], v[188:191], v[36:39], v[144:159]
  v_xor_b32 v48, 0x10000, v48
  v_xor_b32 v49, 0x10000, v49
  v_xor_b32 v50, 0x10000, v50
  v_xor_b32 v51, 0x10000, v51
  v_xor_b32 v52, 0x10000, v52
  v_xor_b32 v53, 0x10000, v53
  v_xor_b32 v54, 0x10000, v54
  v_xor_b32 v55, 0x10000, v55
  v_mov_b32 v3, v63
  s_nop 1
  v_permlane16_swap_b32 v63, v3
  v_add_f32 v63, v63, v3
  v_mov_b32 v3, v63
  s_nop 1
  v_permlane32_swap_b32 v63, v3
  v_add_f32 v63, v63, v3
  ds_write_b32 v58, v63 offset:512
  s_cmp_lg_u32 s3, 0
  s_cbranch_scc1 L_sb_26
  v_lshlrev_b32 v2, 2, v1
  v_mov_b32 v3, 0
  ds_write_b32 v2, v3
  s_nop 0
L_sb_26:
  s_waitcnt lgkmcnt(0)
  s_barrier
  ds_read_b128 v[12:15], v60 offset:512
  v_and_b32 v2, 31, v1
  v_mul_u32_u24 v2, 1040, v2
  v_lshrrev_b32 v3, 5, v1
  v_lshl_add_u32 v2, v3, 3, v2
  s_lshl_b32 s7, s3, 7
  s_add_u32 s7, s7, 65536
  v_add_u32 v2, s7, v2
  s_waitcnt lgkmcnt(0)
  v_add_f32 v12, v12, v13
  v_add_f32 v14, v14, v15
  v_add_f32 v12, v12, v14
  v_rcp_f32 v14, v12
  v_log_f32 v13, v12
  v_mov_b32 v15, v14
  v_fma_f32 v23, v23, s10, v13
  v_pk_mul_f32 v[128:129], v[128:129], v[14:15]
  v_pk_mul_f32 v[130:131], v[130:131], v[14:15]
  v_pk_mul_f32 v[132:133], v[132:133], v[14:15]
  v_pk_mul_f32 v[134:135], v[134:135], v[14:15]
  v_pk_mul_f32 v[136:137], v[136:137], v[14:15]
  v_pk_mul_f32 v[138:139], v[138:139], v[14:15]
  v_pk_mul_f32 v[140:141], v[140:141], v[14:15]
  v_pk_mul_f32 v[142:143], v[142:143], v[14:15]
  v_pk_mul_f32 v[144:145], v[144:145], v[14:15]
  v_pk_mul_f32 v[146:147], v[146:147], v[14:15]
  v_pk_mul_f32 v[148:149], v[148:149], v[14:15]
  v_pk_mul_f32 v[150:151], v[150:151], v[14:15]
  v_pk_mul_f32 v[152:153], v[152:153], v[14:15]
  v_pk_mul_f32 v[154:155], v[154:155], v[14:15]
  v_pk_mul_f32 v[156:157], v[156:157], v[14:15]
  v_pk_mul_f32 v[158:159], v[158:159], v[14:15]
  v_cvt_pk_bf16_f32 v24, v128, v129
  v_cvt_pk_bf16_f32 v25, v130, v131
  ds_write_b64 v2, v[24:25] offset:0
  v_cvt_pk_bf16_f32 v26, v132, v133
  v_cvt_pk_bf16_f32 v27, v134, v135
  ds_write_b64 v2, v[26:27] offset:16
  v_cvt_pk_bf16_f32 v28, v136, v137
  v_cvt_pk_bf16_f32 v29, v138, v139
  ds_write_b64 v2, v[28:29] offset:32
  v_cvt_pk_bf16_f32 v30, v140, v141
  v_cvt_pk_bf16_f32 v31, v142, v143
  ds_write_b64 v2, v[30:31] offset:48
  v_cvt_pk_bf16_f32 v32, v144, v145
  v_cvt_pk_bf16_f32 v33, v146, v147
  ds_write_b64 v2, v[32:33] offset:64
  v_cvt_pk_bf16_f32 v34, v148, v149
  v_cvt_pk_bf16_f32 v35, v150, v151
  ds_write_b64 v2, v[34:35] offset:80
  v_cvt_pk_bf16_f32 v36, v152, v153
  v_cvt_pk_bf16_f32 v37, v154, v155
  ds_write_b64 v2, v[36:37] offset:96
  v_cvt_pk_bf16_f32 v38, v156, v157
  v_cvt_pk_bf16_f32 v39, v158, v159
  ds_write_b64 v2, v[38:39] offset:112
  v_lshlrev_b32 v3, 4, v1
  s_mul_i32 s7, s3, 4160
  s_add_u32 s7, s7, 65536
  v_add_u32 v2, s7, v3
  s_waitcnt lgkmcnt(0)
  s_barrier
  ds_read_b128 v[128:131], v2 offset:0
  ds_read_b128 v[132:135], v2 offset:1040
  ds_read_b128 v[136:139], v2 offset:2080
  ds_read_b128 v[140:143], v2 offset:3120
  v_lshrrev_b32 v4, 3, v1
  v_lshlrev_b32 v4, 13, v4
  v_and_b32 v3, 7, v1
  v_lshl_add_u32 v3, v3, 4, v4
  s_and_b32 s12, s97, 3
  s_lshl_b32 s12, s12, 4
  s_lshr_b32 s13, s97, 2
  s_add_u32 s12, s12, s13
  s_lshl_b32 s12, s12, 7
  s_lshl_b32 s13, s3, 18
  s_add_u32 s13, s13, s12
  s_add_u32 s13, s13, 0x300000
  s_waitcnt lgkmcnt(3)
  buffer_store_dwordx4 v[128:131], v3, s[44:47], s13 offen sc1
  s_add_u32 s13, s13, 65536
  s_waitcnt lgkmcnt(2)
  buffer_store_dwordx4 v[132:135], v3, s[44:47], s13 offen sc1
  s_add_u32 s13, s13, 65536
  s_waitcnt lgkmcnt(1)
  buffer_store_dwordx4 v[136:139], v3, s[44:47], s13 offen sc1
  s_add_u32 s13, s13, 65536
  s_waitcnt lgkmcnt(0)
  buffer_store_dwordx4 v[140:143], v3, s[44:47], s13 offen sc1
  v_lshlrev_b32 v2, 8, v1
  s_lshl_b32 s13, s97, 2
  s_add_u32 s13, s13, 0xc0000
  s_lshl_b32 s7, s3, 2
  s_lshl_b32 exec_lo, 15, s7
  s_mov_b32 exec_hi, 0
  buffer_store_dword v23, v2, s[44:47], s13 offen sc1
  s_mov_b64 exec, 1
  s_lshl_b32 s12, s3, 6
  s_add_u32 s12, s12, s97
  s_lshl_b32 s12, s12, 2
  s_add_u32 s12, s12, 0x3000
  v_mov_b32 v2, 0
  v_mov_b32 v3, s6
  s_waitcnt vmcnt(0)
  buffer_store_dword v3, v2, s[44:47], s12 offen sc1
  s_mov_b64 exec, -1
  s_cmp_lt_u32 s3, 4
  s_cbranch_scc1 L_xa
  v_perm_b32 v96, v196, v192, s8
  v_perm_b32 v97, v204, v200, s8
  v_perm_b32 v98, v212, v208, s8
  v_perm_b32 v99, v220, v216, s8
  v_perm_b32 v100, v196, v192, s9
  v_perm_b32 v101, v204, v200, s9
  v_perm_b32 v102, v212, v208, s9
  v_perm_b32 v103, v220, v216, s9
  v_perm_b32 v104, v197, v193, s8
  v_perm_b32 v105, v205, v201, s8
  v_perm_b32 v106, v213, v209, s8
  v_perm_b32 v107, v221, v217, s8
  v_perm_b32 v108, v197, v193, s9
  v_perm_b32 v109, v205, v201, s9
  v_perm_b32 v110, v213, v209, s9
  v_perm_b32 v111, v221, v217, s9
  v_perm_b32 v112, v198, v194, s8
  v_perm_b32 v113, v206, v202, s8
  v_perm_b32 v114, v214, v210, s8
  v_perm_b32 v115, v222, v218, s8
  v_perm_b32 v116, v198, v194, s9
  v_perm_b32 v117, v206, v202, s9
  v_perm_b32 v118, v214, v210, s9
  v_perm_b32 v119, v222, v218, s9
  v_perm_b32 v120, v199, v195, s8
  v_perm_b32 v121, v207, v203, s8
  v_perm_b32 v122, v215, v211, s8
  v_perm_b32 v123, v223, v219, s8
  v_perm_b32 v124, v199, v195, s9
  v_perm_b32 v125, v207, v203, s9
  v_perm_b32 v126, v215, v211, s9
  v_perm_b32 v127, v223, v219, s9
  v_perm_b32 v128, v228, v224, s8
  v_perm_b32 v129, v236, v232, s8
  v_perm_b32 v130, v244, v240, s8
  v_perm_b32 v131, v252, v248, s8
  v_perm_b32 v132, v228, v224, s9
  v_perm_b32 v133, v236, v232, s9
  v_perm_b32 v134, v244, v240, s9
  v_perm_b32 v135, v252, v248, s9
  v_perm_b32 v136, v229, v225, s8
  v_perm_b32 v137, v237, v233, s8
  v_perm_b32 v138, v245, v241, s8
  v_perm_b32 v139, v253, v249, s8
  v_perm_b32 v140, v229, v225, s9
  v_perm_b32 v141, v237, v233, s9
  v_perm_b32 v142, v245, v241, s9
  v_perm_b32 v143, v253, v249, s9
  v_perm_b32 v144, v230, v226, s8
  v_perm_b32 v145, v238, v234, s8
  v_perm_b32 v146, v246, v242, s8
  v_perm_b32 v147, v254, v250, s8
  v_perm_b32 v148, v230, v226, s9
  v_perm_b32 v149, v238, v234, s9
  v_perm_b32 v150, v246, v242, s9
  v_perm_b32 v151, v254, v250, s9
  v_perm_b32 v152, v231, v227, s8
  v_perm_b32 v153, v239, v235, s8
  v_perm_b32 v154, v247, v243, s8
  v_perm_b32 v155, v255, v251, s8
  v_perm_b32 v156, v231, v227, s9
  v_perm_b32 v157, v239, v235, s9
  v_perm_b32 v158, v247, v243, s9
  v_perm_b32 v159, v255, v251, s9
  s_lshr_b32 s60, s4, 1
  s_lshr_b32 s12, s60, 2
  s_lshl_b32 s12, s12, 8
  s_add_u32 s12, s12, 0x3000
  v_lshlrev_b32 v2, 2, v1
  s_cmp_eq_u32 s3, 4
  s_nop 0
  s_cbranch_scc1 L_bw0_28
  v_mov_b32 v3, 40
  s_mov_b32 s15, 0x4000000
  s_nop 0
L_lw_29:
  ds_read_b32 v2, v3
  s_waitcnt lgkmcnt(0)
  v_readfirstlane_b32 s7, v2
  s_nop 0
  s_cmp_ge_u32 s7, 1
  s_nop 2
  s_cbranch_scc1 L_lwd_30
  s_sleep 2
  s_sub_u32 s15, s15, 1
  s_mov_b32 s14, 29
  s_cmp_eq_u32 s15, 0
  s_cbranch_scc1 L_fail
  s_branch L_lw_29
L_lwd_30:
  s_branch L_bgo_27
L_bw0_28:
  s_mov_b32 s15, 0x400000
L_pf_31:
  buffer_load_dword v3, v2, s[44:47], s12 offen sc1
  s_waitcnt vmcnt(0)
  v_cmp_ne_u32 vcc, s6, v3
  s_nop 4
  s_cbranch_vccz L_pfd_32
  s_mov_b64 exec, vcc
  s_sleep 10
  s_sub_u32 s15, s15, 1
  s_mov_b32 s14, 13
  s_cmp_eq_u32 s15, 0
  s_cbranch_scc1 L_fail
  s_branch L_pf_31
L_pfd_32:
  s_mov_b64 exec, -1
  v_mov_b32 v3, 40
  v_mov_b32 v2, 1
  s_mov_b64 exec, 1
  ds_write_b32 v3, v2
  s_mov_b64 exec, -1
L_bgo_27:
  v_and_b32 v3, 3, v1
  v_lshlrev_b32 v3, 2, v3
  v_bfe_u32 v4, v1, 2, 2
  v_add_u32 v4, v4, v3
  v_lshlrev_b32 v2, 7, v4
  v_lshrrev_b32 v3, 4, v1
  v_lshl_add_u32 v2, v3, 4, v2
  v_lshlrev_b32 v4, 4, v4
  s_lshl_b32 s12, s60, 16
  s_and_b32 s13, s4, 1
  s_lshl_b32 s13, s13, 2
  s_add_u32 s13, s13, s11
  s_lshl_b32 s13, s13, 13
  s_add_u32 s12, s12, s13
  s_add_u32 s12, s12, 0x300000
  s_add_u32 s7, s12, 4096
  s_lshl_b32 s13, s60, 8
  s_add_u32 s13, s13, 0xc0000
  buffer_load_dwordx4 v[8:11], v4, s[44:47], s13 offen sc1
  buffer_load_dwordx4 v[24:27], v2, s[44:47], s12 offen offset:0 sc1
  buffer_load_dwordx4 v[28:31], v2, s[44:47], s12 offen offset:2048 sc1
  buffer_load_dwordx4 v[32:35], v2, s[44:47], s7 offen offset:0 sc1
  buffer_load_dwordx4 v[36:39], v2, s[44:47], s7 offen offset:2048 sc1
  buffer_load_dwordx4 v[40:43], v2, s[44:47], s12 offen offset:64 sc1
  buffer_load_dwordx4 v[44:47], v2, s[44:47], s12 offen offset:2112 sc1
  buffer_load_dwordx4 v[48:51], v2, s[44:47], s7 offen offset:64 sc1
  buffer_load_dwordx4 v[52:55], v2, s[44:47], s7 offen offset:2112 sc1
  s_waitcnt vmcnt(8)
  v_max3_f32 v12, v8, v9, v10
  v_max_f32 v12, v12, v11
  s_nop 1
  v_max_f32_dpp v12, v12, v12 row_ror:8 row_mask:0xf bank_mask:0xf
  s_nop 1
  v_max_f32_dpp v12, v12, v12 row_ror:4 row_mask:0xf bank_mask:0xf
  v_sub_f32 v8, v8, v12
  v_sub_f32 v9, v9, v12
  v_sub_f32 v10, v10, v12
  v_sub_f32 v11, v11, v12
  v_exp_f32 v8, v8
  v_exp_f32 v9, v9
  v_exp_f32 v10, v10
  v_exp_f32 v11, v11
  v_add_f32 v12, v8, v9
  v_add_f32 v13, v10, v11
  v_add_f32 v12, v12, v13
  s_nop 1
  v_add_f32_dpp v12, v12, v12 row_ror:8 row_mask:0xf bank_mask:0xf
  s_nop 1
  v_add_f32_dpp v12, v12, v12 row_ror:4 row_mask:0xf bank_mask:0xf
  v_rcp_f32 v12, v12
  s_nop 0
  v_mul_f32 v8, v8, v12
  v_mul_f32 v9, v9, v12
  v_mul_f32 v10, v10, v12
  v_mul_f32 v11, v11, v12
  s_waitcnt vmcnt(4)
  v_lshlrev_b32 v12, 16, v24
  v_and_b32 v13, 0xffff0000, v24
  v_mul_f32 v16, v12, v8
  v_mul_f32 v17, v13, v8
  v_lshlrev_b32 v12, 16, v25
  v_and_b32 v13, 0xffff0000, v25
  v_mul_f32 v18, v12, v8
  v_mul_f32 v19, v13, v8
  v_lshlrev_b32 v12, 16, v26
  v_and_b32 v13, 0xffff0000, v26
  v_mul_f32 v20, v12, v8
  v_mul_f32 v21, v13, v8
  v_lshlrev_b32 v12, 16, v27
  v_and_b32 v13, 0xffff0000, v27
  v_mul_f32 v22, v12, v8
  v_mul_f32 v23, v13, v8
  v_lshlrev_b32 v12, 16, v28
  v_and_b32 v13, 0xffff0000, v28
  v_fmac_f32 v16, v12, v9
  v_fmac_f32 v17, v13, v9
  v_lshlrev_b32 v12, 16, v29
  v_and_b32 v13, 0xffff0000, v29
  v_fmac_f32 v18, v12, v9
  v_fmac_f32 v19, v13, v9
  v_lshlrev_b32 v12, 16, v30
  v_and_b32 v13, 0xffff0000, v30
  v_fmac_f32 v20, v12, v9
  v_fmac_f32 v21, v13, v9
  v_lshlrev_b32 v12, 16, v31
  v_and_b32 v13, 0xffff0000, v31
  v_fmac_f32 v22, v12, v9
  v_fmac_f32 v23, v13, v9
  v_lshlrev_b32 v12, 16, v32
  v_and_b32 v13, 0xffff0000, v32
  v_fmac_f32 v16, v12, v10
  v_fmac_f32 v17, v13, v10
  v_lshlrev_b32 v12, 16, v33
  v_and_b32 v13, 0xffff0000, v33
  v_fmac_f32 v18, v12, v10
  v_fmac_f32 v19, v13, v10
  v_lshlrev_b32 v12, 16, v34
  v_and_b32 v13, 0xffff0000, v34
  v_fmac_f32 v20, v12, v10
  v_fmac_f32 v21, v13, v10
  v_lshlrev_b32 v12, 16, v35
  v_and_b32 v13, 0xffff0000, v35
  v_fmac_f32 v22, v12, v10
  v_fmac_f32 v23, v13, v10
  v_lshlrev_b32 v12, 16, v36
  v_and_b32 v13, 0xffff0000, v36
  v_fmac_f32 v16, v12, v11
  v_fmac_f32 v17, v13, v11
  v_lshlrev_b32 v12, 16, v37
  v_and_b32 v13, 0xffff0000, v37
  v_fmac_f32 v18, v12, v11
  v_fmac_f32 v19, v13, v11
  v_lshlrev_b32 v12, 16, v38
  v_and_b32 v13, 0xffff0000, v38
  v_fmac_f32 v20, v12, v11
  v_fmac_f32 v21, v13, v11
  v_lshlrev_b32 v12, 16, v39
  v_and_b32 v13, 0xffff0000, v39
  v_fmac_f32 v22, v12, v11
  v_fmac_f32 v23, v13, v11
  v_add_f32_dpp v16, v16, v16 row_ror:8 row_mask:0xf bank_mask:0xf
  v_add_f32_dpp v17, v17, v17 row_ror:8 row_mask:0xf bank_mask:0xf
  v_add_f32_dpp v18, v18, v18 row_ror:8 row_mask:0xf bank_mask:0xf
  v_add_f32_dpp v19, v19, v19 row_ror:8 row_mask:0xf bank_mask:0xf
  v_add_f32_dpp v20, v20, v20 row_ror:8 row_mask:0xf bank_mask:0xf
  v_add_f32_dpp v21, v21, v21 row_ror:8 row_mask:0xf bank_mask:0xf
  v_add_f32_dpp v22, v22, v22 row_ror:8 row_mask:0xf bank_mask:0xf
  v_add_f32_dpp v23, v23, v23 row_ror:8 row_mask:0xf bank_mask:0xf
  v_add_f32_dpp v16, v16, v16 row_ror:4 row_mask:0xf bank_mask:0xf
  v_add_f32_dpp v17, v17, v17 row_ror:4 row_mask:0xf bank_mask:0xf
  v_add_f32_dpp v18, v18, v18 row_ror:4 row_mask:0xf bank_mask:0xf
  v_add_f32_dpp v19, v19, v19 row_ror:4 row_mask:0xf bank_mask:0xf
  v_add_f32_dpp v20, v20, v20 row_ror:4 row_mask:0xf bank_mask:0xf
  v_add_f32_dpp v21, v21, v21 row_ror:4 row_mask:0xf bank_mask:0xf
  v_add_f32_dpp v22, v22, v22 row_ror:4 row_mask:0xf bank_mask:0xf
  v_add_f32_dpp v23, v23, v23 row_ror:4 row_mask:0xf bank_mask:0xf
  v_cvt_pk_bf16_f32 v4, v16, v17
  v_cvt_pk_bf16_f32 v5, v18, v19
  v_cvt_pk_bf16_f32 v6, v20, v21
  v_cvt_pk_bf16_f32 v7, v22, v23
  s_nop 1
  v_mfma_f32_16x16x32_bf16 v[56:59], v[4:7], v[96:99], 0
  v_mfma_f32_16x16x32_bf16 v[60:63], v[4:7], v[100:103], 0
  v_mfma_f32_16x16x32_bf16 v[64:67], v[4:7], v[104:107], 0
  v_mfma_f32_16x16x32_bf16 v[68:71], v[4:7], v[108:111], 0
  v_mfma_f32_16x16x32_bf16 v[72:75], v[4:7], v[112:115], 0
  v_mfma_f32_16x16x32_bf16 v[76:79], v[4:7], v[116:119], 0
  v_mfma_f32_16x16x32_bf16 v[80:83], v[4:7], v[120:123], 0
  v_mfma_f32_16x16x32_bf16 v[84:87], v[4:7], v[124:127], 0
  s_waitcnt vmcnt(0)
  v_lshlrev_b32 v12, 16, v40
  v_and_b32 v13, 0xffff0000, v40
  v_mul_f32 v16, v12, v8
  v_mul_f32 v17, v13, v8
  v_lshlrev_b32 v12, 16, v41
  v_and_b32 v13, 0xffff0000, v41
  v_mul_f32 v18, v12, v8
  v_mul_f32 v19, v13, v8
  v_lshlrev_b32 v12, 16, v42
  v_and_b32 v13, 0xffff0000, v42
  v_mul_f32 v20, v12, v8
  v_mul_f32 v21, v13, v8
  v_lshlrev_b32 v12, 16, v43
  v_and_b32 v13, 0xffff0000, v43
  v_mul_f32 v22, v12, v8
  v_mul_f32 v23, v13, v8
  v_lshlrev_b32 v12, 16, v44
  v_and_b32 v13, 0xffff0000, v44
  v_fmac_f32 v16, v12, v9
  v_fmac_f32 v17, v13, v9
  v_lshlrev_b32 v12, 16, v45
  v_and_b32 v13, 0xffff0000, v45
  v_fmac_f32 v18, v12, v9
  v_fmac_f32 v19, v13, v9
  v_lshlrev_b32 v12, 16, v46
  v_and_b32 v13, 0xffff0000, v46
  v_fmac_f32 v20, v12, v9
  v_fmac_f32 v21, v13, v9
  v_lshlrev_b32 v12, 16, v47
  v_and_b32 v13, 0xffff0000, v47
  v_fmac_f32 v22, v12, v9
  v_fmac_f32 v23, v13, v9
  v_lshlrev_b32 v12, 16, v48
  v_and_b32 v13, 0xffff0000, v48
  v_fmac_f32 v16, v12, v10
  v_fmac_f32 v17, v13, v10
  v_lshlrev_b32 v12, 16, v49
  v_and_b32 v13, 0xffff0000, v49
  v_fmac_f32 v18, v12, v10
  v_fmac_f32 v19, v13, v10
  v_lshlrev_b32 v12, 16, v50
  v_and_b32 v13, 0xffff0000, v50
  v_fmac_f32 v20, v12, v10
  v_fmac_f32 v21, v13, v10
  v_lshlrev_b32 v12, 16, v51
  v_and_b32 v13, 0xffff0000, v51
  v_fmac_f32 v22, v12, v10
  v_fmac_f32 v23, v13, v10
  v_lshlrev_b32 v12, 16, v52
  v_and_b32 v13, 0xffff0000, v52
  v_fmac_f32 v16, v12, v11
  v_fmac_f32 v17, v13, v11
  v_lshlrev_b32 v12, 16, v53
  v_and_b32 v13, 0xffff0000, v53
  v_fmac_f32 v18, v12, v11
  v_fmac_f32 v19, v13, v11
  v_lshlrev_b32 v12, 16, v54
  v_and_b32 v13, 0xffff0000, v54
  v_fmac_f32 v20, v12, v11
  v_fmac_f32 v21, v13, v11
  v_lshlrev_b32 v12, 16, v55
  v_and_b32 v13, 0xffff0000, v55
  v_fmac_f32 v22, v12, v11
  v_fmac_f32 v23, v13, v11
  v_add_f32_dpp v16, v16, v16 row_ror:8 row_mask:0xf bank_mask:0xf
  v_add_f32_dpp v17, v17, v17 row_ror:8 row_mask:0xf bank_mask:0xf
  v_add_f32_dpp v18, v18, v18 row_ror:8 row_mask:0xf bank_mask:0xf
  v_add_f32_dpp v19, v19, v19 row_ror:8 row_mask:0xf bank_mask:0xf
  v_add_f32_dpp v20, v20, v20 row_ror:8 row_mask:0xf bank_mask:0xf
  v_add_f32_dpp v21, v21, v21 row_ror:8 row_mask:0xf bank_mask:0xf
  v_add_f32_dpp v22, v22, v22 row_ror:8 row_mask:0xf bank_mask:0xf
  v_add_f32_dpp v23, v23, v23 row_ror:8 row_mask:0xf bank_mask:0xf
  v_add_f32_dpp v16, v16, v16 row_ror:4 row_mask:0xf bank_mask:0xf
  v_add_f32_dpp v17, v17, v17 row_ror:4 row_mask:0xf bank_mask:0xf
  v_add_f32_dpp v18, v18, v18 row_ror:4 row_mask:0xf bank_mask:0xf
  v_add_f32_dpp v19, v19, v19 row_ror:4 row_mask:0xf bank_mask:0xf
  v_add_f32_dpp v20, v20, v20 row_ror:4 row_mask:0xf bank_mask:0xf
  v_add_f32_dpp v21, v21, v21 row_ror:4 row_mask:0xf bank_mask:0xf
  v_add_f32_dpp v22, v22, v22 row_ror:4 row_mask:0xf bank_mask:0xf
  v_add_f32_dpp v23, v23, v23 row_ror:4 row_mask:0xf bank_mask:0xf
  v_cvt_pk_bf16_f32 v4, v16, v17
  v_cvt_pk_bf16_f32 v5, v18, v19
  v_cvt_pk_bf16_f32 v6, v20, v21
  v_cvt_pk_bf16_f32 v7, v22, v23
  s_nop 1
  v_mfma_f32_16x16x32_bf16 v[56:59], v[4:7], v[128:131], v[56:59]
  v_mfma_f32_16x16x32_bf16 v[60:63], v[4:7], v[132:135], v[60:63]
  v_mfma_f32_16x16x32_bf16 v[64:67], v[4:7], v[136:139], v[64:67]
  v_mfma_f32_16x16x32_bf16 v[68:71], v[4:7], v[140:143], v[68:71]
  v_mfma_f32_16x16x32_bf16 v[72:75], v[4:7], v[144:147], v[72:75]
  v_mfma_f32_16x16x32_bf16 v[76:79], v[4:7], v[148:151], v[76:79]
  v_mfma_f32_16x16x32_bf16 v[80:83], v[4:7], v[152:155], v[80:83]
  v_mfma_f32_16x16x32_bf16 v[84:87], v[4:7], v[156:159], v[84:87]
  s_mul_i32 s7, s11, 2048
  s_add_u32 s7, s7, 256
  v_lshlrev_b32 v2, 4, v1
  v_add_u32 v2, s7, v2
  s_mov_b64 exec, 0xffff
  ds_write_b128 v2, v[56:59] offset:0
  ds_write_b128 v2, v[60:63] offset:256
  ds_write_b128 v2, v[64:67] offset:512
  ds_write_b128 v2, v[68:71] offset:768
  ds_write_b128 v2, v[72:75] offset:1024
  ds_write_b128 v2, v[76:79] offset:1280
  ds_write_b128 v2, v[80:83] offset:1536
  ds_write_b128 v2, v[84:87] offset:1792
  s_mov_b64 exec, -1
  v_mov_b32 v3, 12
  v_mov_b32 v2, 1
  s_mov_b64 exec, 1
  ds_add_rtn_u32 v2, v3, v2
  s_waitcnt lgkmcnt(0)
  v_readfirstlane_b32 s12, v2
  s_mov_b64 exec, -1
  s_cmp_lg_u32 s12, 3
  s_nop 2
  s_cbranch_scc1 L_bs_33
  v_and_b32 v2, 15, v1
  v_lshlrev_b32 v2, 4, v2
  v_lshrrev_b32 v24, 4, v1
  v_lshl_add_u32 v2, v24, 2, v2
  ds_read_b32 v24, v2 offset:256
  ds_read_b32 v25, v2 offset:512
  ds_read_b32 v26, v2 offset:768
  ds_read_b32 v27, v2 offset:1024
  ds_read_b32 v28, v2 offset:1280
  ds_read_b32 v29, v2 offset:1536
  ds_read_b32 v30, v2 offset:1792
  ds_read_b32 v31, v2 offset:2048
  ds_read_b32 v32, v2 offset:2304
  ds_read_b32 v33, v2 offset:2560
  ds_read_b32 v34, v2 offset:2816
  ds_read_b32 v35, v2 offset:3072
  ds_read_b32 v36, v2 offset:3328
  ds_read_b32 v37, v2 offset:3584
  ds_read_b32 v38, v2 offset:3840
  ds_read_b32 v39, v2 offset:4096
  ds_read_b32 v40, v2 offset:4352
  ds_read_b32 v41, v2 offset:4608
  ds_read_b32 v42, v2 offset:4864
  ds_read_b32 v43, v2 offset:5120
  ds_read_b32 v44, v2 offset:5376
  ds_read_b32 v45, v2 offset:5632
  ds_read_b32 v46, v2 offset:5888
  ds_read_b32 v47, v2 offset:6144
  ds_read_b32 v48, v2 offset:6400
  ds_read_b32 v49, v2 offset:6656
  ds_read_b32 v50, v2 offset:6912
  ds_read_b32 v51, v2 offset:7168
  ds_read_b32 v52, v2 offset:7424
  ds_read_b32 v53, v2 offset:7680
  ds_read_b32 v54, v2 offset:7936
  ds_read_b32 v55, v2 offset:8192
  s_waitcnt lgkmcnt(0)
  v_add_f32 v24, v24, v32
  v_add_f32 v40, v40, v48
  v_add_f32 v25, v25, v33
  v_add_f32 v41, v41, v49
  v_add_f32 v26, v26, v34
  v_add_f32 v42, v42, v50
  v_add_f32 v27, v27, v35
  v_add_f32 v43, v43, v51
  v_add_f32 v28, v28, v36
  v_add_f32 v44, v44, v52
  v_add_f32 v29, v29, v37
  v_add_f32 v45, v45, v53
  v_add_f32 v30, v30, v38
  v_add_f32 v46, v46, v54
  v_add_f32 v31, v31, v39
  v_add_f32 v47, v47, v55
  v_add_f32 v8, v24, v40
  v_add_f32 v9, v25, v41
  v_add_f32 v10, v26, v42
  v_add_f32 v12, v27, v43
  v_add_f32 v13, v28, v44
  v_add_f32 v14, v29, v45
  v_add_f32 v16, v30, v46
  v_add_f32 v17, v31, v47
  v_add_f32 v8, v8, v8
  v_add_f32 v9, v9, v9
  v_add_f32 v10, v10, v10
  v_add_f32 v12, v12, v12
  v_add_f32 v13, v13, v13
  v_add_f32 v14, v14, v14
  v_add_f32 v16, v16, v16
  v_add_f32 v17, v17, v17
  v_mov_b32 v18, 0
  v_mov_b32 v11, s6
  v_mov_b32 v15, s6
  v_mov_b32 v19, s6
  v_lshrrev_b32 v3, 4, v1
  v_mul_u32_u24 v2, 3072, v3
  v_and_b32 v3, 15, v1
  v_lshl_add_u32 v2, v3, 4, v2
  s_mul_i32 s12, s60, 12288
  s_and_b32 s13, s4, 1
  s_mul_i32 s13, s13, 768
  s_add_u32 s12, s12, s13
  s_add_u32 s12, s12, 0x130000
  buffer_store_dwordx4 v[8:11], v2, s[44:47], s12 offen offset:0 sc1
  buffer_store_dwordx4 v[12:15], v2, s[44:47], s12 offen offset:256 sc1
  buffer_store_dwordx4 v[16:19], v2, s[44:47], s12 offen offset:512 sc1
  s_nop 1
L_bs_33:
  s_endpgm
L_xa:
L_out:
  s_lshr_b32 s60, s4, 1
  v_and_b32 v2, 15, v1
  v_mul_u32_u24 v44, 768, v2
  v_lshrrev_b32 v3, 4, v1
  v_lshl_add_u32 v44, v3, 4, v44
  v_lshrrev_b32 v3, 4, v1
  v_mul_u32_u24 v45, 8192, v3
  v_and_b32 v3, 15, v1
  v_lshl_add_u32 v45, v3, 4, v45
  s_lshl_b32 s12, s96, 5
  s_add_u32 s12, s12, s60
  s_mul_i32 s12, s12, 12288
  s_lshl_b32 s13, s11, 6
  s_add_u32 s12, s12, s13
  s_add_u32 s61, s12, 0xd0000
  v_lshlrev_b32 v2, 4, v1
  s_mul_i32 s7, s11, 6144
  v_add_u32 v46, s7, v2
  s_lshl_b32 s7, s11, 11
  v_add_u32 v47, s7, v2
  s_and_b32 s12, s4, 1
  s_mul_i32 s12, s12, 3
  s_add_u32 s12, s12, s11
  s_mul_i32 s13, s96, 6
  s_add_u32 s12, s12, s13
  s_lshl_b32 s12, s12, 16
  s_lshl_b32 s13, s60, 8
  s_add_u32 s12, s12, s13
  s_add_u32 s62, s12, 0x190000
  s_mov_b32 s12, 0x77777777
  s_cmp_eq_u32 s96, 1
  s_cselect_b32 s66, 0x33333333, s12
  s_mov_b32 s67, s66
  s_cmp_eq_u32 s96, 1
  s_cbranch_scc1 L_onw_34
  s_waitcnt vmcnt(18)
  v_perm_b32 v88, v204, v192, s8
  v_perm_b32 v92, v204, v192, s9
  v_perm_b32 v96, v205, v193, s8
  v_perm_b32 v100, v205, v193, s9
  v_perm_b32 v104, v206, v194, s8
  v_perm_b32 v108, v206, v194, s9
  v_perm_b32 v112, v207, v195, s8
  v_perm_b32 v116, v207, v195, s9
  v_perm_b32 v120, v208, v196, s8
  v_perm_b32 v124, v208, v196, s9
  v_perm_b32 v128, v209, v197, s8
  v_perm_b32 v132, v209, v197, s9
  v_perm_b32 v136, v210, v198, s8
  v_perm_b32 v140, v210, v198, s9
  v_perm_b32 v144, v211, v199, s8
  v_perm_b32 v148, v211, v199, s9
  v_perm_b32 v152, v212, v200, s8
  v_perm_b32 v156, v212, v200, s9
  s_waitcnt vmcnt(12)
  v_perm_b32 v89, v228, v216, s8
  v_perm_b32 v93, v228, v216, s9
  v_perm_b32 v97, v229, v217, s8
  v_perm_b32 v101, v229, v217, s9
  v_perm_b32 v105, v230, v218, s8
  v_perm_b32 v109, v230, v218, s9
  v_perm_b32 v113, v231, v219, s8
  v_perm_b32 v117, v231, v219, s9
  v_perm_b32 v121, v232, v220, s8
  v_perm_b32 v125, v232, v220, s9
  v_perm_b32 v129, v233, v221, s8
  v_perm_b32 v133, v233, v221, s9
  v_perm_b32 v137, v234, v222, s8
  v_perm_b32 v141, v234, v222, s9
  v_perm_b32 v145, v235, v223, s8
  v_perm_b32 v149, v235, v223, s9
  v_perm_b32 v153, v236, v224, s8
  v_perm_b32 v157, v236, v224, s9
  s_waitcnt vmcnt(6)
  v_perm_b32 v90, v252, v240, s8
  v_perm_b32 v94, v252, v240, s9
  v_perm_b32 v98, v253, v241, s8
  v_perm_b32 v102, v253, v241, s9
  v_perm_b32 v106, v254, v242, s8
  v_perm_b32 v110, v254, v242, s9
  v_perm_b32 v114, v255, v243, s8
  v_perm_b32 v118, v255, v243, s9
  v_perm_b32 v122, v160, v244, s8
  v_perm_b32 v126, v160, v244, s9
  v_perm_b32 v130, v161, v245, s8
  v_perm_b32 v134, v161, v245, s9
  v_perm_b32 v138, v162, v246, s8
  v_perm_b32 v142, v162, v246, s9
  v_perm_b32 v146, v163, v247, s8
  v_perm_b32 v150, v163, v247, s9
  v_perm_b32 v154, v164, v248, s8
  v_perm_b32 v158, v164, v248, s9
  s_waitcnt vmcnt(0)
  v_perm_b32 v91, v180, v168, s8
  v_perm_b32 v95, v180, v168, s9
  v_perm_b32 v99, v181, v169, s8
  v_perm_b32 v103, v181, v169, s9
  v_perm_b32 v107, v182, v170, s8
  v_perm_b32 v111, v182, v170, s9
  v_perm_b32 v115, v183, v171, s8
  v_perm_b32 v119, v183, v171, s9
  v_perm_b32 v123, v184, v172, s8
  v_perm_b32 v127, v184, v172, s9
  v_perm_b32 v131, v185, v173, s8
  v_perm_b32 v135, v185, v173, s9
  v_perm_b32 v139, v186, v174, s8
  v_perm_b32 v143, v186, v174, s9
  v_perm_b32 v147, v187, v175, s8
  v_perm_b32 v151, v187, v175, s9
  v_perm_b32 v155, v188, v176, s8
  v_perm_b32 v159, v188, v176, s9
  s_nop 1
L_onw_34:
  s_mov_b32 s68, 0
  s_mov_b32 s63, 0x40000000
  s_mov_b32 s64, 0x40000000
  s_mov_b32 s65, 28
  v_mov_b32 v48, 28
  v_mov_b32 v49, 1
  s_nop 1
  s_branch L_opost_35
L_oreal_36:
  v_mov_b32 v48, 32
  s_mov_b64 exec, 1
  ds_add_u32 v48, v49
  s_mov_b64 exec, -1
  v_mov_b32 v3, 32
  s_mov_b32 s15, 0x4000000
  s_nop 0
L_lw_37:
  ds_read_b32 v2, v3
  s_waitcnt lgkmcnt(0)
  v_readfirstlane_b32 s7, v2
  s_nop 0
  s_cmp_ge_u32 s7, 4
  s_nop 2
  s_cbranch_scc1 L_lwd_38
  s_sleep 1
  s_sub_u32 s15, s15, 1
  s_mov_b32 s14, 24
  s_cmp_eq_u32 s15, 0
  s_cbranch_scc1 L_fail
  s_branch L_lw_37
L_lwd_38:
  s_mov_b32 s68, 1
  s_mov_b32 s63, s62
  s_add_u32 s64, s63, 32768
  s_mov_b32 s65, 24
  v_mov_b32 v48, 24
  v_mov_b32 v28, 0
  v_mov_b32 v29, 0
  v_mov_b32 v30, 0
  v_mov_b32 v32, 0
  v_mov_b32 v33, 0
  v_mov_b32 v34, 0
  v_mov_b32 v36, 0
  v_mov_b32 v37, 0
  v_mov_b32 v38, 0xff800000
  s_cmp_eq_u32 s96, 1
  s_cselect_b32 s12, 12, 8
  s_cselect_b32 s13, 4, 8
  v_mov_b32 v3, s12
  s_mov_b32 s15, 0x4000000
  s_nop 0
L_lw_39:
  ds_read_b32 v2, v3
  s_waitcnt lgkmcnt(0)
  v_readfirstlane_b32 s7, v2
  s_nop 0
  s_cmp_ge_u32 s7, s13
  s_nop 2
  s_cbranch_scc1 L_lwd_40
  s_sleep 1
  s_sub_u32 s15, s15, 1
  s_mov_b32 s14, 21
  s_cmp_eq_u32 s15, 0
  s_cbranch_scc1 L_fail
  s_branch L_lw_39
L_lwd_40:
  s_mov_b64 exec, s[66:67]
  s_mov_b32 s15, 0x400000
L_pg_41:
  buffer_load_dwordx4 v[28:31], v44, s[44:47], s61 offen offset:0 sc1
  buffer_load_dwordx4 v[32:35], v44, s[44:47], s61 offen offset:256 sc1
  buffer_load_dwordx4 v[36:39], v44, s[44:47], s61 offen offset:512 sc1
  s_waitcnt vmcnt(0)
  v_and_b32 v40, v31, v35
  v_or_b32 v41, v31, v35
  v_and_b32 v40, v40, v39
  v_or_b32 v41, v41, v39
  v_xor_b32 v40, s6, v40
  v_xor_b32 v41, s6, v41
  v_or_b32 v40, v40, v41
  v_cmp_ne_u32 vcc, 0, v40
  s_nop 4
  s_cbranch_vccz L_pgd_42
  s_mov_b64 exec, vcc
  s_sub_u32 s15, s15, 1
  s_mov_b32 s14, 14
  s_cmp_eq_u32 s15, 0
  s_cbranch_scc1 L_fail
  s_bcnt1_i32_b64 s7, vcc
  s_cmp_le_u32 s7, 16
  s_cbranch_scc1 L_pg_41
  s_sleep 8
  s_branch L_pg_41
L_pgd_42:
  s_mov_b64 exec, -1
L_opost_35:
  v_max_f32_dpp v40, v38, v38 quad_perm:[1,0,3,2] row_mask:0xf bank_mask:0xf
  s_nop 1
  v_max_f32_dpp v40, v40, v40 quad_perm:[2,3,0,1] row_mask:0xf bank_mask:0xf
  v_sub_f32 v40, v38, v40
  v_exp_f32 v40, v40
  s_nop 1
  v_add_f32_dpp v41, v40, v40 quad_perm:[1,0,3,2] row_mask:0xf bank_mask:0xf
  v_mul_f32 v28, v28, v40
  v_mul_f32 v29, v29, v40
  v_mul_f32 v30, v30, v40
  v_mul_f32 v32, v32, v40
  v_mul_f32 v33, v33, v40
  v_mul_f32 v34, v34, v40
  v_mul_f32 v36, v36, v40
  v_mul_f32 v37, v37, v40
  v_add_f32_dpp v41, v41, v41 quad_perm:[2,3,0,1] row_mask:0xf bank_mask:0xf
  v_add_f32_dpp v28, v28, v28 quad_perm:[1,0,3,2] row_mask:0xf bank_mask:0xf
  v_add_f32_dpp v29, v29, v29 quad_perm:[1,0,3,2] row_mask:0xf bank_mask:0xf
  v_add_f32_dpp v30, v30, v30 quad_perm:[1,0,3,2] row_mask:0xf bank_mask:0xf
  v_add_f32_dpp v32, v32, v32 quad_perm:[1,0,3,2] row_mask:0xf bank_mask:0xf
  v_add_f32_dpp v33, v33, v33 quad_perm:[1,0,3,2] row_mask:0xf bank_mask:0xf
  v_add_f32_dpp v34, v34, v34 quad_perm:[1,0,3,2] row_mask:0xf bank_mask:0xf
  v_add_f32_dpp v36, v36, v36 quad_perm:[1,0,3,2] row_mask:0xf bank_mask:0xf
  v_add_f32_dpp v37, v37, v37 quad_perm:[1,0,3,2] row_mask:0xf bank_mask:0xf
  v_rcp_f32 v41, v41
  v_add_f32_dpp v28, v28, v28 quad_perm:[2,3,0,1] row_mask:0xf bank_mask:0xf
  v_add_f32_dpp v29, v29, v29 quad_perm:[2,3,0,1] row_mask:0xf bank_mask:0xf
  v_add_f32_dpp v30, v30, v30 quad_perm:[2,3,0,1] row_mask:0xf bank_mask:0xf
  v_add_f32_dpp v32, v32, v32 quad_perm:[2,3,0,1] row_mask:0xf bank_mask:0xf
  v_add_f32_dpp v33, v33, v33 quad_perm:[2,3,0,1] row_mask:0xf bank_mask:0xf
  v_add_f32_dpp v34, v34, v34 quad_perm:[2,3,0,1] row_mask:0xf bank_mask:0xf
  v_add_f32_dpp v36, v36, v36 quad_perm:[2,3,0,1] row_mask:0xf bank_mask:0xf
  v_add_f32_dpp v37, v37, v37 quad_perm:[2,3,0,1] row_mask:0xf bank_mask:0xf
  v_mul_f32 v28, v28, v41
  v_mul_f32 v29, v29, v41
  v_mul_f32 v30, v30, v41
  v_mul_f32 v32, v32, v41
  v_mul_f32 v33, v33, v41
  v_mul_f32 v34, v34, v41
  v_mul_f32 v36, v36, v41
  v_mul_f32 v37, v37, v41
  v_cvt_pk_bf16_f32 v24, v28, v29
  v_cvt_pk_bf16_f32 v25, v30, v32
  v_cvt_pk_bf16_f32 v26, v33, v34
  v_cvt_pk_bf16_f32 v27, v36, v37
  s_and_b32 s7, s96, s68
  s_cmp_eq_u32 s7, 0
  s_cbranch_scc1 L_ohw_43
  s_cmp_eq_u32 s3, 0
  s_cbranch_scc1 L_dw0_45
  v_mov_b32 v3, 36
  s_mov_b32 s15, 0x4000000
  s_nop 0
L_lw_46:
  ds_read_b32 v2, v3
  s_waitcnt lgkmcnt(0)
  v_readfirstlane_b32 s7, v2
  s_nop 0
  s_cmp_ge_u32 s7, 1
  s_nop 2
  s_cbranch_scc1 L_lwd_47
  s_sleep 4
  s_sub_u32 s15, s15, 1
  s_mov_b32 s14, 28
  s_cmp_eq_u32 s15, 0
  s_cbranch_scc1 L_fail
  s_branch L_lw_46
L_lwd_47:
  s_branch L_dgo_44
L_dw0_45:
  v_mov_b32 v3, 0
  s_lshl_b32 s12, s4, 8
  s_add_u32 s12, s12, 0x4000
  s_mov_b32 s15, 0x400000
  s_mov_b64 exec, 1
L_dlp_48:
  buffer_load_dword v2, v3, s[44:47], s12 offen sc1
  s_waitcnt vmcnt(0)
  v_readfirstlane_b32 s7, v2
  s_nop 0
  s_cmp_ge_u32 s7, 68
  s_nop 2
  s_cbranch_scc1 L_dld_49
  s_sleep 6
  s_sub_u32 s15, s15, 1
  s_mov_b32 s14, 25
  s_cmp_eq_u32 s15, 0
  s_cbranch_scc1 L_fail
  s_branch L_dlp_48
L_dld_49:
  s_mov_b64 exec, -1
  v_mov_b32 v3, 36
  v_mov_b32 v2, 1
  s_mov_b64 exec, 1
  ds_write_b32 v3, v2
  s_mov_b64 exec, -1
L_dgo_44:
  s_cmp_eq_u32 s96, 0
  s_cselect_b32 s56, s24, s36
  s_cselect_b32 s57, s25, s37
  s_mov_b32 s58, 4718592
  s_mov_b32 s59, 0x20000
  s_lshr_b32 s7, s4, 1
  s_lshl_b32 s7, s7, 2
  s_add_u32 s7, s7, s11
  s_mul_i32 s7, s7, 36864
  s_and_b32 s12, s4, 1
  s_mul_i32 s13, s12, 640
  s_lshl_b32 s12, s12, 6
  s_add_u32 s12, s12, 512
  v_lshrrev_b32 v3, 4, v1
  v_mul_u32_u24 v43, 9216, v3
  v_and_b32 v3, 15, v1
  v_lshl_add_u32 v2, v3, 4, v43
  v_add_u32 v2, s13, v2
  v_lshl_add_u32 v3, v3, 2, v43
  v_add_u32 v3, s12, v3
  buffer_load_dwordx4 v[192:195], v2, s[56:59], s7 offen offset:0 nt
  buffer_load_dwordx4 v[196:199], v2, s[56:59], s7 offen offset:256 nt
  buffer_load_dword v200, v3, s[56:59], s7 offen offset:0 nt
  buffer_load_dwordx4 v[204:207], v2, s[56:59], s7 offen offset:1152 nt
  buffer_load_dwordx4 v[208:211], v2, s[56:59], s7 offen offset:1408 nt
  buffer_load_dword v212, v3, s[56:59], s7 offen offset:1152 nt
  buffer_load_dwordx4 v[216:219], v2, s[56:59], s7 offen offset:2304 nt
  buffer_load_dwordx4 v[220:223], v2, s[56:59], s7 offen offset:2560 nt
  buffer_load_dword v224, v3, s[56:59], s7 offen offset:2304 nt
  s_add_u32 s7, s7, 3456
  buffer_load_dwordx4 v[228:231], v2, s[56:59], s7 offen offset:0 nt
  buffer_load_dwordx4 v[232:235], v2, s[56:59], s7 offen offset:256 nt
  buffer_load_dword v236, v3, s[56:59], s7 offen offset:0 nt
  buffer_load_dwordx4 v[240:243], v2, s[56:59], s7 offen offset:1152 nt
  buffer_load_dwordx4 v[244:247], v2, s[56:59], s7 offen offset:1408 nt
  buffer_load_dword v248, v3, s[56:59], s7 offen offset:1152 nt
  buffer_load_dwordx4 v[252:255], v2, s[56:59], s7 offen offset:2304 nt
  buffer_load_dwordx4 v[160:163], v2, s[56:59], s7 offen offset:2560 nt
  buffer_load_dword v164, v3, s[56:59], s7 offen offset:2304 nt
  s_add_u32 s7, s7, 3456
  buffer_load_dwordx4 v[168:171], v2, s[56:59], s7 offen offset:0 nt
  buffer_load_dwordx4 v[172:175], v2, s[56:59], s7 offen offset:256 nt
  buffer_load_dword v176, v3, s[56:59], s7 offen offset:0 nt
  buffer_load_dwordx4 v[180:183], v2, s[56:59], s7 offen offset:1152 nt
  buffer_load_dwordx4 v[184:187], v2, s[56:59], s7 offen offset:1408 nt
  buffer_load_dword v188, v3, s[56:59], s7 offen offset:1152 nt
  s_waitcnt vmcnt(18)
  v_perm_b32 v88, v204, v192, s8
  v_perm_b32 v92, v204, v192, s9
  v_perm_b32 v96, v205, v193, s8
  v_perm_b32 v100, v205, v193, s9
  v_perm_b32 v104, v206, v194, s8
  v_perm_b32 v108, v206, v194, s9
  v_perm_b32 v112, v207, v195, s8
  v_perm_b32 v116, v207, v195, s9
  v_perm_b32 v120, v208, v196, s8
  v_perm_b32 v124, v208, v196, s9
  v_perm_b32 v128, v209, v197, s8
  v_perm_b32 v132, v209, v197, s9
  v_perm_b32 v136, v210, v198, s8
  v_perm_b32 v140, v210, v198, s9
  v_perm_b32 v144, v211, v199, s8
  v_perm_b32 v148, v211, v199, s9
  v_perm_b32 v152, v212, v200, s8
  v_perm_b32 v156, v212, v200, s9
  s_waitcnt vmcnt(12)
  v_perm_b32 v89, v228, v216, s8
  v_perm_b32 v93, v228, v216, s9
  v_perm_b32 v97, v229, v217, s8
  v_perm_b32 v101, v229, v217, s9
  v_perm_b32 v105, v230, v218, s8
  v_perm_b32 v109, v230, v218, s9
  v_perm_b32 v113, v231, v219, s8
  v_perm_b32 v117, v231, v219, s9
  v_perm_b32 v121, v232, v220, s8
  v_perm_b32 v125, v232, v220, s9
  v_perm_b32 v129, v233, v221, s8
  v_perm_b32 v133, v233, v221, s9
  v_perm_b32 v137, v234, v222, s8
  v_perm_b32 v141, v234, v222, s9
  v_perm_b32 v145, v235, v223, s8
  v_perm_b32 v149, v235, v223, s9
  v_perm_b32 v153, v236, v224, s8
  v_perm_b32 v157, v236, v224, s9
  s_waitcnt vmcnt(6)
  v_perm_b32 v90, v252, v240, s8
  v_perm_b32 v94, v252, v240, s9
  v_perm_b32 v98, v253, v241, s8
  v_perm_b32 v102, v253, v241, s9
  v_perm_b32 v106, v254, v242, s8
  v_perm_b32 v110, v254, v242, s9
  v_perm_b32 v114, v255, v243, s8
  v_perm_b32 v118, v255, v243, s9
  v_perm_b32 v122, v160, v244, s8
  v_perm_b32 v126, v160, v244, s9
  v_perm_b32 v130, v161, v245, s8
  v_perm_b32 v134, v161, v245, s9
  v_perm_b32 v138, v162, v246, s8
  v_perm_b32 v142, v162, v246, s9
  v_perm_b32 v146, v163, v247, s8
  v_perm_b32 v150, v163, v247, s9
  v_perm_b32 v154, v164, v248, s8
  v_perm_b32 v158, v164, v248, s9
  s_waitcnt vmcnt(0)
  v_perm_b32 v91, v180, v168, s8
  v_perm_b32 v95, v180, v168, s9
  v_perm_b32 v99, v181, v169, s8
  v_perm_b32 v103, v181, v169, s9
  v_perm_b32 v107, v182, v170, s8
  v_perm_b32 v111, v182, v170, s9
  v_perm_b32 v115, v183, v171, s8
  v_perm_b32 v119, v183, v171, s9
  v_perm_b32 v123, v184, v172, s8
  v_perm_b32 v127, v184, v172, s9
  v_perm_b32 v131, v185, v173, s8
  v_perm_b32 v135, v185, v173, s9
  v_perm_b32 v139, v186, v174, s8
  v_perm_b32 v143, v186, v174, s9
  v_perm_b32 v147, v187, v175, s8
  v_perm_b32 v151, v187, v175, s9
  v_perm_b32 v155, v188, v176, s8
  v_perm_b32 v159, v188, v176, s9
  s_nop 1
L_ohw_43:
  v_mfma_f32_16x16x32_bf16 v[160:163], v[24:27], v[88:91], 0
  v_mfma_f32_16x16x32_bf16 v[164:167], v[24:27], v[92:95], 0
  v_mfma_f32_16x16x32_bf16 v[168:171], v[24:27], v[96:99], 0
  v_mfma_f32_16x16x32_bf16 v[172:175], v[24:27], v[100:103], 0
  v_mfma_f32_16x16x32_bf16 v[176:179], v[24:27], v[104:107], 0
  v_mfma_f32_16x16x32_bf16 v[180:183], v[24:27], v[108:111], 0
  v_mfma_f32_16x16x32_bf16 v[184:187], v[24:27], v[112:115], 0
  v_mfma_f32_16x16x32_bf16 v[188:191], v[24:27], v[116:119], 0
  v_mfma_f32_16x16x32_bf16 v[192:195], v[24:27], v[120:123], 0
  s_nop 0
  v_mov_b32 v161, v164
  v_mov_b32 v162, v168
  ds_write_b128 v46, v[160:163] offset:16384
  v_mfma_f32_16x16x32_bf16 v[196:199], v[24:27], v[124:127], 0
  v_mfma_f32_16x16x32_bf16 v[200:203], v[24:27], v[128:131], 0
  v_mfma_f32_16x16x32_bf16 v[204:207], v[24:27], v[132:135], 0
  v_mov_b32 v173, v176
  v_mov_b32 v174, v180
  ds_write_b128 v46, v[172:175] offset:17408
  v_mfma_f32_16x16x32_bf16 v[208:211], v[24:27], v[136:139], 0
  v_mfma_f32_16x16x32_bf16 v[212:215], v[24:27], v[140:143], 0
  v_mfma_f32_16x16x32_bf16 v[216:219], v[24:27], v[144:147], 0
  v_mov_b32 v185, v188
  v_mov_b32 v186, v192
  ds_write_b128 v46, v[184:187] offset:18432
  v_mfma_f32_16x16x32_bf16 v[220:223], v[24:27], v[148:151], 0
  v_mfma_f32_16x16x32_bf16 v[224:227], v[24:27], v[152:155], 0
  v_mfma_f32_16x16x32_bf16 v[228:231], v[24:27], v[156:159], 0
  v_mov_b32 v197, v200
  v_mov_b32 v198, v204
  ds_write_b128 v46, v[196:199] offset:19456
  v_mov_b32 v209, v212
  v_mov_b32 v210, v216
  ds_write_b128 v46, v[208:211] offset:20480
  s_nop 0
  v_mov_b32 v221, v224
  v_mov_b32 v222, v228
  ds_write_b128 v46, v[220:223] offset:21504
  s_cmp_eq_u32 s68, 0
  s_cbranch_scc1 L_onb_51
  s_waitcnt lgkmcnt(0)
  s_barrier
L_onb_51:
  s_cmp_eq_u32 s11, 3
  s_cbranch_scc1 L_os_50
  ds_read_b128 v[52:55], v47 offset:16384
  ds_read_b128 v[56:59], v47 offset:22528
  ds_read_b128 v[60:63], v47 offset:28672
  ds_read_b128 v[64:67], v47 offset:34816
  ds_read_b128 v[68:71], v47 offset:17408
  ds_read_b128 v[72:75], v47 offset:23552
  ds_read_b128 v[76:79], v47 offset:29696
  ds_read_b128 v[80:83], v47 offset:35840
  s_waitcnt lgkmcnt(4)
  v_add_f32 v52, v52, v56
  v_add_f32 v60, v60, v64
  v_add_f32 v53, v53, v57
  v_add_f32 v61, v61, v65
  v_add_f32 v54, v54, v58
  v_add_f32 v62, v62, v66
  v_mov_b32 v55, s6
  v_add_f32 v52, v52, v60
  v_add_f32 v53, v53, v61
  v_add_f32 v54, v54, v62
  buffer_store_dwordx4 v[52:55], v45, s[44:47], s63 offen sc1
  s_waitcnt lgkmcnt(0)
  v_add_f32 v68, v68, v72
  v_add_f32 v76, v76, v80
  v_add_f32 v69, v69, v73
  v_add_f32 v77, v77, v81
  v_add_f32 v70, v70, v74
  v_add_f32 v78, v78, v82
  v_mov_b32 v71, s6
  v_add_f32 v68, v68, v76
  v_add_f32 v69, v69, v77
  v_add_f32 v70, v70, v78
  buffer_store_dwordx4 v[68:71], v45, s[44:47], s64 offen sc1
  s_nop 1
L_os_50:
  s_cmp_eq_u32 s68, 0
  s_cbranch_scc1 L_oreal_36
  s_cmp_eq_u32 s96, 0
  s_cbranch_scc1 L_endw
  s_cmp_lg_u32 s11, 3
  s_cbranch_scc1 L_endw
L_fin:
  s_cmp_ge_u32 s4, 48
  s_cbranch_scc1 L_fd_52
  s_mul_i32 s12, s96, 48
  s_add_u32 s12, s12, s4
  s_lshl_b32 s12, s12, 13
  s_add_u32 s61, s12, 0x190000
  s_add_u32 s64, s61, 4096
  v_lshlrev_b32 v2, 4, v1
  s_mov_b32 s48, s38
  s_mov_b32 s49, s39
  s_mov_b32 s50, 0x2400
  s_mov_b32 s51, 0x20000
  s_and_b32 s12, s4, 3
  s_mul_i32 s12, s12, 2304
  s_mul_i32 s13, s96, 1152
  s_add_u32 s65, s12, s13
  s_lshr_b32 s68, s4, 2
  s_cmp_ge_u32 s68, 6
  s_cselect_b32 s67, 1, 0
  s_mul_i32 s7, s67, 6
  s_sub_u32 s68, s68, s7
  s_mul_i32 s68, s68, 3
  s_lshr_b32 s7, s68, 3
  s_lshl_b32 s7, s7, 8
  s_mul_i32 s12, s67, 640
  s_add_u32 s7, s7, s12
  s_lshl_b32 s12, s67, 6
  s_add_u32 s12, s12, 512
  s_cmp_lt_u32 s68, 16
  s_cselect_b32 s7, s7, s12
  s_cselect_b32 s13, 4, 2
  s_and_b32 s12, s68, 7
  s_lshl_b32 s12, s12, 1
  s_add_u32 s7, s7, s12
  v_lshlrev_b32 v4, s13, v1
  v_add_u32 v4, s7, v4
  s_add_u32 s68, s68, 1
  s_lshr_b32 s7, s68, 3
  s_lshl_b32 s7, s7, 8
  s_mul_i32 s12, s67, 640
  s_add_u32 s7, s7, s12
  s_lshl_b32 s12, s67, 6
  s_add_u32 s12, s12, 512
  s_cmp_lt_u32 s68, 16
  s_cselect_b32 s7, s7, s12
  s_cselect_b32 s13, 4, 2
  s_and_b32 s12, s68, 7
  s_lshl_b32 s12, s12, 1
  s_add_u32 s7, s7, s12
  v_lshlrev_b32 v40, s13, v1
  v_add_u32 v40, s7, v40
  s_add_u32 s68, s68, 1
  s_lshr_b32 s7, s68, 3
  s_lshl_b32 s7, s7, 8
  s_mul_i32 s12, s67, 640
  s_add_u32 s7, s7, s12
  s_lshl_b32 s12, s67, 6
  s_add_u32 s12, s12, 512
  s_cmp_lt_u32 s68, 16
  s_cselect_b32 s7, s7, s12
  s_cselect_b32 s13, 4, 2
  s_and_b32 s12, s68, 7
  s_lshl_b32 s12, s12, 1
  s_add_u32 s7, s7, s12
  v_lshlrev_b32 v41, s13, v1
  v_add_u32 v41, s7, v41
  s_add_u32 s68, s68, 1
  s_mov_b32 s66, 0x40000000
  s_branch L_fpost_53
L_freal_54:
  s_mov_b32 s66, s65
  s_cmp_eq_u32 s96, 1
  s_cbranch_scc1 L_fnb_55
  v_mov_b32 v6, 8
  s_mov_b32 s15, 0x4000000
  s_nop 0
L_lw_56:
  ds_read_b32 v5, v6
  s_waitcnt lgkmcnt(0)
  v_readfirstlane_b32 s7, v5
  s_nop 0
  s_cmp_ge_u32 s7, 8
  s_nop 2
  s_cbranch_scc1 L_lwd_57
  s_sleep 2
  s_sub_u32 s15, s15, 1
  s_mov_b32 s14, 27
  s_cmp_eq_u32 s15, 0
  s_cbranch_scc1 L_fail
  s_branch L_lw_56
L_lwd_57:
L_fnb_55:
  v_lshlrev_b32 v6, 8, v1
  s_mov_b32 s15, 0x400000
  s_mov_b32 exec_hi, 0
L_fl_58:
  buffer_load_dword v5, v6, s[44:47], s61 offen offset:12 sc1
  s_waitcnt vmcnt(0)
  v_cmp_ne_u32 vcc, s6, v5
  s_nop 0
  s_bcnt1_i32_b64 s7, vcc
  s_cmp_le_u32 s7, 8
  s_nop 1
  s_cbranch_scc1 L_fld_59
  s_mov_b64 exec, vcc
  s_sleep 4
  s_sub_u32 s15, s15, 1
  s_mov_b32 s14, 16
  s_cmp_eq_u32 s15, 0
  s_cbranch_scc1 L_fail
  s_branch L_fl_58
L_fld_59:
  s_mov_b64 exec, -1
  s_mov_b32 s15, 0x400000
L_pg_60:
  buffer_load_dwordx4 v[8:11], v2, s[44:47], s61 offen offset:0 sc1
  buffer_load_dwordx4 v[12:15], v2, s[44:47], s61 offen offset:1024 sc1
  buffer_load_dwordx4 v[16:19], v2, s[44:47], s61 offen offset:2048 sc1
  buffer_load_dwordx4 v[20:23], v2, s[44:47], s61 offen offset:3072 sc1
  buffer_load_dwordx4 v[24:27], v2, s[44:47], s64 offen offset:0 sc1
  buffer_load_dwordx4 v[28:31], v2, s[44:47], s64 offen offset:1024 sc1
  buffer_load_dwordx4 v[32:35], v2, s[44:47], s64 offen offset:2048 sc1
  buffer_load_dwordx4 v[36:39], v2, s[44:47], s64 offen offset:3072 sc1
  s_waitcnt vmcnt(0)
  v_and_b32 v5, v11, v15
  v_or_b32 v6, v11, v15
  v_and_b32 v5, v5, v19
  v_and_b32 v5, v5, v23
  v_and_b32 v5, v5, v27
  v_and_b32 v5, v5, v31
  v_and_b32 v5, v5, v35
  v_and_b32 v5, v5, v39
  v_or3_b32 v6, v6, v19, v23
  v_or3_b32 v6, v6, v27, v31
  v_or3_b32 v6, v6, v35, v39
  v_xor_b32 v5, s6, v5
  v_xor_b32 v6, s6, v6
  v_or_b32 v5, v5, v6
  v_cmp_ne_u32 vcc, 0, v5
  s_nop 4
  s_cbranch_vccz L_pgd_61
  s_mov_b64 exec, vcc
  s_sub_u32 s15, s15, 1
  s_mov_b32 s14, 17
  s_cmp_eq_u32 s15, 0
  s_cbranch_scc1 L_fail
  s_branch L_pg_60
L_pgd_61:
  s_mov_b64 exec, -1
L_fpost_53:
  v_add_f32 v8, v8, v24
  v_add_f32 v9, v9, v25
  v_add_f32 v10, v10, v26
  v_add_f32 v12, v12, v28
  v_add_f32 v13, v13, v29
  v_add_f32 v14, v14, v30
  v_add_f32 v16, v16, v32
  v_add_f32 v17, v17, v33
  v_add_f32 v18, v18, v34
  v_add_f32 v20, v20, v36
  v_add_f32 v21, v21, v37
  v_add_f32 v22, v22, v38
  v_add_f32 v8, v8, v16
  v_add_f32 v9, v9, v17
  v_add_f32 v10, v10, v18
  v_add_f32 v12, v12, v20
  v_add_f32 v13, v13, v21
  v_add_f32 v14, v14, v22
  v_add_f32 v8, v8, v12
  v_add_f32 v9, v9, v13
  v_add_f32 v10, v10, v14
  v_mov_b32 v12, v8
  v_mov_b32 v13, v9
  v_mov_b32 v14, v10
  v_permlane16_swap_b32 v8, v12
  v_permlane16_swap_b32 v9, v13
  v_permlane16_swap_b32 v10, v14
  v_add_f32 v8, v8, v12
  v_add_f32 v9, v9, v13
  v_add_f32 v10, v10, v14
  v_mov_b32 v12, v8
  v_mov_b32 v13, v9
  v_mov_b32 v14, v10
  v_permlane32_swap_b32 v8, v12
  v_permlane32_swap_b32 v9, v13
  v_permlane32_swap_b32 v10, v14
  v_add_f32 v8, v8, v12
  v_add_f32 v9, v9, v13
  v_add_f32 v10, v10, v14
  v_cvt_pk_bf16_f32 v8, v8, v9
  v_cvt_pk_bf16_f32 v10, v10, v10
  s_mov_b64 exec, 0xffff
  buffer_store_short v8, v4, s[48:51], s66 offen
  buffer_store_short_d16_hi v8, v40, s[48:51], s66 offen
  buffer_store_short v10, v41, s[48:51], s66 offen
  s_mov_b64 exec, -1
  s_cmp_eq_u32 s66, 0x40000000
  s_cbranch_scc1 L_freal_54
  s_lshl_b32 s7, s4, 1
  s_add_u32 s7, s7, s96
  s_cmp_lg_u32 s7, 1
  s_cbranch_scc1 L_fd_52
  s_mov_b64 exec, 1
  v_mov_b32 v2, 0
  v_mov_b32 v3, s6
  buffer_store_dword v3, v2, s[44:47], 0 offen offset:0 sc1
  s_mov_b64 exec, -1
L_fd_52:
L_endw:
  s_endpgm
L_fail:
  s_mov_b64 exec, 1
  v_mov_b32 v2, 4
  v_mov_b32 v3, s14
  global_store_dword v2, v3, s[40:41]
  s_nop 0
L_exit:
  s_endpgm
L_code1:
.fill 64, 4, 0xBF800000
.section .rodata,"a"
.p2align 6
.amdhsa_kernel concat_heads__gqa_block_cached__compressed_kv_cla__decode_kernel
  .amdhsa_next_free_vgpr 256
  .amdhsa_next_free_sgpr 102
  .amdhsa_accum_offset 256
  .amdhsa_group_segment_fixed_size 0
  .amdhsa_kernarg_size 112
  .amdhsa_user_sgpr_count 2
  .amdhsa_user_sgpr_kernarg_segment_ptr 1
  .amdhsa_system_sgpr_workgroup_id_x 1
.end_amdhsa_kernel
```
